```python
import torch

def _softmax(x, axis=-1):
    return torch.softmax(x, dim=axis)
def _gelu(x):
    return torch.nn.functional.gelu(x, approximate="tanh")
def _silu(x):
    return torch.nn.functional.silu(x)
def _sigmoid(x):
    return torch.sigmoid(x)
def _layernorm(x, axis=-1, eps=1e-5):
    m = x.mean(dim=axis, keepdim=True)
    v = x.var(dim=axis, keepdim=True, unbiased=False)
    return (x - m) / torch.sqrt(v + eps)
def _scatter_add(tgt, idx, src, axis=0):
    return tgt.clone().index_add_(axis, idx, src)
def _segment_sum(src, seg, n):
    out = torch.zeros((n,) + src.shape[1:], dtype=src.dtype)
    return out.index_add_(0, seg, src)
def _pad(x, pw):
    flat = tuple(v for pair in reversed(pw) for v in pair)
    return torch.nn.functional.pad(x, flat)

kernel_name = 'parallel_sum__ssm_conv_h3__dense_activation_gelu__prompt'

def setup_inputs():

    _w = (lambda a: (lambda t: t.to(torch.bfloat16) if t.is_floating_point() else t)(torch.as_tensor(a)))
    def _A_setup():
        B, S, D = 1, 2048, 640
        ks = 4
        return {
            "q": _w((lambda *s: torch.randn(*s, dtype=torch.bfloat16) * 0.05)(B, S, D)),
            "k": _w((lambda *s: torch.randn(*s, dtype=torch.bfloat16) * 0.2)(B, S, D)),
            "v": _w((lambda *s: torch.randn(*s, dtype=torch.bfloat16) * 0.2)(B, S, D)),
            "shift_k": _w((lambda *s: torch.randn(*s, dtype=torch.bfloat16) * 0.2)(D, ks) * 0.5),
            "ssm_k": _w((lambda *s: torch.randn(*s, dtype=torch.bfloat16) * 0.8)(D, S) * (1.0 / S ** 0.5)),
            "ssm_D": _w((lambda *s: torch.randn(*s, dtype=torch.bfloat16) * 0.2)(D)),
        }
    _A_in = _A_setup()

    def _B_setup():
        B, S, D, F = 1, 2048, 640, 1728
        return {
            "x": _w((lambda *s: torch.randn(*s, dtype=torch.bfloat16) * 0.05)(B, S, D)),
            "w1": _w((lambda *s: torch.randn(*s, dtype=torch.bfloat16) * 0.4)(D, F) * (D ** -0.5)),
            "b1": _w((lambda *s: torch.randn(*s, dtype=torch.bfloat16) * 12.8)(F) * 0.01),
            "w2": _w((lambda *s: torch.randn(*s, dtype=torch.bfloat16) * 0.2)(F, D) * (F ** -0.5)),
            "b2": _w((lambda *s: torch.randn(*s, dtype=torch.bfloat16) * 1.6)(D) * 0.01),
        }
    _B_in = _B_setup()

    return {
        "A_q": _A_in["q"],
        "A_k": _A_in["k"],
        "A_v": _A_in["v"],
        "A_shift_k": _A_in["shift_k"],
        "A_ssm_k": _A_in["ssm_k"],
        "A_ssm_D": _A_in["ssm_D"],
        "B_x": _B_in["x"],
        "B_w1": _B_in["w1"],
        "B_b1": _B_in["b1"],
        "B_w2": _B_in["w2"],
        "B_b2": _B_in["b2"],
    }

def reference(A_q, A_k, A_v, A_shift_k, A_ssm_k, A_ssm_D, B_x, B_w1, B_b1, B_w2, B_b2):
    def _A_ref(q, k, v, shift_k, ssm_k, ssm_D):
        B, S, D = q.shape
        ks = shift_k.shape[-1]
        k_pad = _pad(k, ((0, 0), (ks - 1, 0), (0, 0)))
        k_shift = torch.zeros_like(k)
        for t in range(ks):
            k_shift = k_shift + k_pad[:, t:t + S, :] * shift_k[:, ks - 1 - t][None, None, :]
        kv = k_shift * v
        L = 2 * S
        kv_pad = _pad(kv, ((0, 0), (0, S), (0, 0)))
        kf_pad = _pad(ssm_k, ((0, 0), (0, S)))
        kv_f = (lambda x, axes=(-2,-1): torch.fft.rfft2(x.float(), dim=axes))(kv_pad[:, None, :, :], axes=(1, 2))
        kf_f = (lambda x, axes=(-2,-1): torch.fft.rfft2(x.float(), dim=axes))(kf_pad[:, None, :], axes=(1, 2))
        kf_f = (lambda x, *d: x.permute(*d))(kf_f, 1, 2, 0)
        y_f = kv_f * kf_f[None, :, :, :]
        y = (lambda x, s, axes=(-2,-1): torch.fft.irfft2(x, s=s, dim=axes).to(torch.bfloat16))(y_f, (1, L), axes=(1, 2))[:, 0, :S, :]
        y = y + kv * ssm_D[None, None, :]
        return q * y

    def _B_ref(x, w1, b1, w2, b2):
        h = torch.einsum("bsd,df->bsf", x, w1) + b1
        h = _gelu(h)
        return torch.einsum("bsf,fd->bsd", h, w2) + b2

    x = A_q
    xn = _layernorm(x, axis=-1)
    return x + _A_ref(xn, A_k, A_v, A_shift_k, A_ssm_k, A_ssm_D) + _B_ref(xn, B_w1, B_b1, B_w2, B_b2)
```

```asm
; @launch grid=(256,1,1) block=(512,1,1) lds=163840
.amdgcn_target "amdgcn-amd-amdhsa--gfx950"
.text
.globl parallel_sum__ssm_conv_h3__dense_activation_gelu__prompt_kernel
.p2align 8
.type parallel_sum__ssm_conv_h3__dense_activation_gelu__prompt_kernel,@function
parallel_sum__ssm_conv_h3__dense_activation_gelu__prompt_kernel:
    s_cmp_ge_u32 s2, 256
    s_cbranch_scc1 L_end
    s_load_dwordx16 s[72:87], s[0:1], 0
    s_load_dwordx8 s[88:95], s[0:1], 64
    s_load_dwordx2 s[96:97], s[0:1], 104
    v_lshrrev_b32 v1, 6, v0
    v_lshrrev_b32 v15, 5, v0
    v_and_b32 v16, 31, v0
    v_and_b32 v0, 63, v0
    v_readfirstlane_b32 s52, v1
    v_and_b32 v1, 15, v0
    v_lshrrev_b32 v2, 4, v0
    v_lshlrev_b32 v3, 4, v0
    s_and_b32 s53, s2, 7
    s_lshr_b32 s54, s2, 3
    s_mov_b32 s6, 2621440
    s_mov_b32 s7, 0x20000
    s_mov_b32 s10, 2621440
    s_mov_b32 s11, 0x20000
    s_mov_b32 s14, 2621440
    s_mov_b32 s15, 0x20000
    s_mov_b32 s18, 5120
    s_mov_b32 s19, 0x20000
    s_mov_b32 s22, 2621440
    s_mov_b32 s23, 0x20000
    s_mov_b32 s26, 1280
    s_mov_b32 s27, 0x20000
    s_mov_b32 s30, 2211840
    s_mov_b32 s31, 0x20000
    s_mov_b32 s34, 3456
    s_mov_b32 s35, 0x20000
    s_mov_b32 s38, 2211840
    s_mov_b32 s39, 0x20000
    s_mov_b32 s42, 1280
    s_mov_b32 s43, 0x20000
    s_mov_b32 s46, 2621440
    s_mov_b32 s47, 0x20000
    s_mov_b32 s50, 17825792
    s_mov_b32 s51, 0x20000
    s_mul_i32 s64, s54, 37
    s_lshr_b32 s64, s64, 8
    s_lshr_b32 s62, s53, 1
    s_lshl_b32 s55, s62, 2
    s_add_u32 s55, s55, s64
    s_min_u32 s55, s55, 15
    s_and_b32 s63, s53, 1
    s_sub_u32 s56, s63, s64
    s_mul_i32 s56, s56, 7
    s_add_u32 s56, s56, s54
    s_lshl_b32 s59, s62, 3
    s_lshr_b32 s64, s54, 2
    s_add_u32 s59, s59, s64
    s_lshl_b32 s60, s63, 2
    s_and_b32 s64, s54, 3
    s_add_u32 s60, s60, s64
    s_mul_i32 s58, s53, 28
    s_add_u32 s58, s58, s54
    s_lshl_b32 s62, s53, 2
    s_add_u32 s62, s62, s54
    s_mul_i32 s62, s62, 3
    s_add_u32 s62, s62, 140
    s_cmp_lt_u32 s54, 28
    s_cselect_b32 s58, s58, s62
    s_cselect_b32 s57, 1, 3
    v_mov_b32 v20, 1073741824
    v_lshrrev_b32 v21, 3, v0
    v_and_b32 v22, 7, v0
    s_cmp_ge_u32 s52, 4
    s_waitcnt lgkmcnt(0)
    s_mov_b64 s[4:5], s[72:73]
    s_mov_b64 s[8:9], s[74:75]
    s_mov_b64 s[12:13], s[76:77]
    s_mov_b64 s[16:17], s[78:79]
    s_mov_b64 s[20:21], s[80:81]
    s_mov_b64 s[24:25], s[82:83]
    s_mov_b64 s[28:29], s[86:87]
    s_mov_b64 s[32:33], s[88:89]
    s_mov_b64 s[36:37], s[90:91]
    s_mov_b64 s[40:41], s[92:93]
    s_mov_b64 s[44:45], s[94:95]
    s_mov_b64 s[48:49], s[96:97]
    s_load_dword s68, s[48:49], 0
    s_cbranch_scc1 L_role_L
    s_setprio 1
    v_mul_u32_u24 v23, 1280, v21
    v_lshl_add_u32 v23, v22, 4, v23
    v_cmp_gt_u32 vcc, 24, v0
    s_nop 1
    v_cndmask_b32 v17, v20, v23, vcc
    v_lshlrev_b32 v14, 4, v16
    s_mul_i32 s67, s52, 5120
    s_mul_i32 s70, s52, 20480
    s_mov_b32 s61, 0
L_stg:
    s_sub_u32 s73, s61, 1
    s_mul_i32 s73, s73, 20480
    s_cmp_eq_u32 s61, 0
    s_cselect_b32 s73, 98304, s73
    s_add_u32 s73, s73, s67
    s_add_u32 s62, s58, s61
    s_and_b32 s63, s62, 31
    s_mul_i32 s63, s63, 81920
    s_add_u32 s63, s63, s70
    s_cmp_eq_u32 s63, 0
    s_cselect_b32 s65, 3840, 0
    s_lshr_b32 s62, s62, 5
    s_lshl_b32 s64, s62, 7
    s_add_u32 s63, s63, s64
    v_subrev_u32 v18, s65, v23
    v_cmp_gt_i32 vcc, 0, v18
    s_add_u32 s64, s63, s65
    s_sub_u32 s64, s64, 3840
    v_cndmask_b32 v18, v18, v20, vcc
    s_mov_b32 m0, s73
    s_lshl_b32 s62, s62, 9
    buffer_load_dwordx4 v18, s[8:11], s64 offen lds
    s_add_u32 s64, s63, 6400
    s_add_u32 m0, s73, 1024
    s_add_u32 s65, s63, 16640
    buffer_load_dwordx4 v23, s[8:11], s64 offen lds
    s_add_u32 m0, s73, 2048
    s_add_u32 s64, s63, 10240
    buffer_load_dwordx4 v17, s[8:11], s65 offen lds
    s_add_u32 m0, s73, 3072
    s_add_u32 s61, s61, 1
    buffer_load_dwordx4 v23, s[12:15], s63 offen lds
    s_add_u32 m0, s73, 4096
    s_cmp_eq_u32 s61, 2
    buffer_load_dwordx4 v23, s[12:15], s64 offen lds
    s_cbranch_scc1 L_stg_b
    s_cmp_eq_u32 s61, 3
    s_cbranch_scc1 L_stg_c
    buffer_load_dwordx4 v[172:175], v14, s[16:19], s62 offen
    s_cmp_eq_u32 s57, 1
    s_cbranch_scc1 L_stg_done
    s_branch L_stg
L_stg_b:
    buffer_load_dwordx4 v[176:179], v14, s[16:19], s62 offen
    s_branch L_stg
L_stg_c:
    buffer_load_dwordx4 v[180:183], v14, s[16:19], s62 offen
L_stg_done:
    s_lshl_b32 s62, s56, 8
    v_lshlrev_b32 v17, 3, v2
    s_xor_b32 s63, s52, 0
    s_lshl_b32 s63, s63, 6
    s_add_u32 s63, s63, s62
    buffer_load_dwordx2 v[84:85], v17, s[32:35], s63 offen offset:0
    buffer_load_dwordx2 v[86:87], v17, s[32:35], s63 offen offset:32
    s_xor_b32 s63, s52, 1
    s_lshl_b32 s63, s63, 6
    s_add_u32 s63, s63, s62
    buffer_load_dwordx2 v[88:89], v17, s[32:35], s63 offen offset:0
    buffer_load_dwordx2 v[90:91], v17, s[32:35], s63 offen offset:32
    s_xor_b32 s63, s52, 2
    s_lshl_b32 s63, s63, 6
    s_add_u32 s63, s63, s62
    buffer_load_dwordx2 v[92:93], v17, s[32:35], s63 offen offset:0
    buffer_load_dwordx2 v[94:95], v17, s[32:35], s63 offen offset:32
    s_xor_b32 s63, s52, 3
    s_lshl_b32 s63, s63, 6
    s_add_u32 s63, s63, s62
    buffer_load_dwordx2 v[96:97], v17, s[32:35], s63 offen offset:0
    buffer_load_dwordx2 v[98:99], v17, s[32:35], s63 offen offset:32
    v_and_b32 v21, 7, v1
    v_xor_b32 v21, v21, v2
    v_lshlrev_b32 v21, 4, v21
    v_lshl_add_u32 v21, v1, 7, v21
    s_lshl_b32 s62, s52, 12
    v_add_u32 v4, s62, v21
    v_xor_b32 v5, 64, v4
    v_lshrrev_b32 v21, 2, v0
    v_and_b32 v22, 7, v21
    s_lshl_b32 s62, s52, 1
    v_xor_b32 v22, s62, v22
    v_lshlrev_b32 v22, 5, v22
    v_and_b32 v21, 3, v21
    v_lshl_add_u32 v21, v2, 3, v21
    v_lshl_add_u32 v22, v21, 8, v22
    v_and_b32 v21, 3, v0
    v_lshl_add_u32 v22, v21, 3, v22
    v_add_u32 v6, 16384, v22
    v_and_b32 v14, 1, v15
    v_lshlrev_b32 v14, 10, v14
    v_lshl_add_u32 v14, v16, 2, v14
    v_add_u32 v14, s67, v14
    v_sub_u32 v17, 7, v15
    v_xor_b32 v17, v17, v16
    v_and_b32 v17, 7, v17
    v_lshlrev_b32 v17, 4, v17
    v_lshl_add_u32 v17, v16, 8, v17
    v_xor_b32 v7, 32, v6
    v_xor_b32 v8, 64, v6
    v_xor_b32 v9, 96, v6
    v_xor_b32 v10, 128, v6
    v_xor_b32 v11, 160, v6
    v_xor_b32 v12, 192, v6
    v_xor_b32 v13, 224, v6
    v_mov_b32 v184, 0
    v_mov_b32 v185, 0
    v_mov_b32 v186, 0
    v_mov_b32 v187, 0
    v_mov_b32 v188, 0
    v_mov_b32 v189, 0
    v_mov_b32 v190, 0
    v_mov_b32 v191, 0
    v_mov_b32 v192, 0
    v_mov_b32 v193, 0
    v_mov_b32 v194, 0
    v_mov_b32 v195, 0
    v_mov_b32 v196, 0
    v_mov_b32 v197, 0
    v_mov_b32 v198, 0
    v_mov_b32 v199, 0
    v_mov_b32 v200, 0
    v_mov_b32 v201, 0
    v_mov_b32 v202, 0
    v_mov_b32 v203, 0
    v_mov_b32 v204, 0
    v_mov_b32 v205, 0
    v_mov_b32 v206, 0
    v_mov_b32 v207, 0
    v_mov_b32 v208, 0
    v_mov_b32 v209, 0
    v_mov_b32 v210, 0
    v_mov_b32 v211, 0
    v_mov_b32 v212, 0
    v_mov_b32 v213, 0
    v_mov_b32 v214, 0
    v_mov_b32 v215, 0
    v_mov_b32 v216, 0
    v_mov_b32 v217, 0
    v_mov_b32 v218, 0
    v_mov_b32 v219, 0
    v_mov_b32 v220, 0
    v_mov_b32 v221, 0
    v_mov_b32 v222, 0
    v_mov_b32 v223, 0
    v_mov_b32 v224, 0
    v_mov_b32 v225, 0
    v_mov_b32 v226, 0
    v_mov_b32 v227, 0
    v_mov_b32 v228, 0
    v_mov_b32 v229, 0
    v_mov_b32 v230, 0
    v_mov_b32 v231, 0
    v_mov_b32 v232, 0
    v_mov_b32 v233, 0
    v_mov_b32 v234, 0
    v_mov_b32 v235, 0
    v_mov_b32 v236, 0
    v_mov_b32 v237, 0
    v_mov_b32 v238, 0
    v_mov_b32 v239, 0
    v_mov_b32 v240, 0
    v_mov_b32 v241, 0
    v_mov_b32 v242, 0
    v_mov_b32 v243, 0
    v_mov_b32 v244, 0
    v_mov_b32 v245, 0
    v_mov_b32 v246, 0
    v_mov_b32 v247, 0
    v_mov_b32 v248, 0
    v_mov_b32 v249, 0
    v_mov_b32 v250, 0
    v_mov_b32 v251, 0
    v_mov_b32 v252, 0
    v_mov_b32 v253, 0
    v_mov_b32 v254, 0
    v_mov_b32 v255, 0
    v_mov_b32 v100, 0x3f803f80
    v_mov_b32 v101, 0x3f803f80
    v_mov_b32 v102, 0x3f803f80
    v_mov_b32 v103, 0x3f803f80
    s_mov_b32 s61, 0
    s_waitcnt vmcnt(8)
L_kv:
    s_sub_u32 s73, s61, 1
    s_mul_i32 s73, s73, 20480
    s_cmp_eq_u32 s61, 0
    s_cselect_b32 s73, 98304, s73
    v_add_u32 v21, s73, v14
    v_add_u32 v22, 1024, v21
    v_add_u32 v23, 3072, v21
    ds_read2_b32 v[104:105], v21 offset0:0 offset1:32
    ds_read2_b32 v[106:107], v21 offset0:64 offset1:96
    ds_read2_b32 v[108:109], v21 offset0:128 offset1:160
    ds_read2_b32 v[110:111], v21 offset0:192 offset1:224
    ds_read2_b32 v[112:113], v22 offset0:0 offset1:32
    ds_read_b32 v114, v22 offset:256
    ds_read2_b32 v[116:117], v23 offset0:0 offset1:32
    ds_read2_b32 v[118:119], v23 offset0:64 offset1:96
    ds_read2_b32 v[120:121], v23 offset0:128 offset1:160
    ds_read2_b32 v[122:123], v23 offset0:192 offset1:224
    v_lshlrev_b32 v124, 16, v172
    v_lshlrev_b32 v125, 16, v174
    v_and_b32 v126, 0xffff0000, v172
    v_and_b32 v127, 0xffff0000, v174
    v_lshlrev_b32 v128, 16, v173
    v_lshlrev_b32 v129, 16, v175
    v_and_b32 v130, 0xffff0000, v173
    v_and_b32 v131, 0xffff0000, v175
    s_mul_i32 s73, s61, 8192
    s_add_u32 s73, s73, 32768
    s_cmp_eq_u32 s61, 0
    s_cselect_b32 s73, 118784, s73
    v_add_u32 v21, s73, v17
    s_waitcnt lgkmcnt(4)
    v_lshlrev_b32 v132, 16, v104
    v_and_b32 v133, 0xffff0000, v104
    v_lshlrev_b32 v134, 16, v105
    v_and_b32 v135, 0xffff0000, v105
    v_lshlrev_b32 v136, 16, v106
    v_and_b32 v137, 0xffff0000, v106
    v_lshlrev_b32 v138, 16, v107
    v_and_b32 v139, 0xffff0000, v107
    v_lshlrev_b32 v140, 16, v108
    v_and_b32 v141, 0xffff0000, v108
    v_lshlrev_b32 v142, 16, v109
    v_and_b32 v143, 0xffff0000, v109
    v_lshlrev_b32 v144, 16, v110
    v_and_b32 v145, 0xffff0000, v110
    v_lshlrev_b32 v146, 16, v111
    v_and_b32 v147, 0xffff0000, v111
    v_lshlrev_b32 v148, 16, v112
    v_and_b32 v149, 0xffff0000, v112
    v_lshlrev_b32 v150, 16, v113
    v_and_b32 v151, 0xffff0000, v113
    v_lshlrev_b32 v152, 16, v114
    v_and_b32 v153, 0xffff0000, v114
    v_pk_mul_f32 v[156:157], v[138:139], v[124:125]
    v_pk_mul_f32 v[158:159], v[140:141], v[124:125]
    v_pk_mul_f32 v[160:161], v[142:143], v[124:125]
    v_pk_mul_f32 v[162:163], v[144:145], v[124:125]
    v_pk_mul_f32 v[164:165], v[146:147], v[124:125]
    v_pk_mul_f32 v[166:167], v[148:149], v[124:125]
    v_pk_mul_f32 v[168:169], v[150:151], v[124:125]
    v_pk_mul_f32 v[170:171], v[152:153], v[124:125]
    v_pk_fma_f32 v[156:157], v[136:137], v[126:127], v[156:157]
    v_pk_fma_f32 v[158:159], v[138:139], v[126:127], v[158:159]
    v_pk_fma_f32 v[160:161], v[140:141], v[126:127], v[160:161]
    v_pk_fma_f32 v[162:163], v[142:143], v[126:127], v[162:163]
    v_pk_fma_f32 v[164:165], v[144:145], v[126:127], v[164:165]
    v_pk_fma_f32 v[166:167], v[146:147], v[126:127], v[166:167]
    v_pk_fma_f32 v[168:169], v[148:149], v[126:127], v[168:169]
    v_pk_fma_f32 v[170:171], v[150:151], v[126:127], v[170:171]
    v_pk_fma_f32 v[156:157], v[134:135], v[128:129], v[156:157]
    v_pk_fma_f32 v[158:159], v[136:137], v[128:129], v[158:159]
    v_pk_fma_f32 v[160:161], v[138:139], v[128:129], v[160:161]
    v_pk_fma_f32 v[162:163], v[140:141], v[128:129], v[162:163]
    v_pk_fma_f32 v[164:165], v[142:143], v[128:129], v[164:165]
    v_pk_fma_f32 v[166:167], v[144:145], v[128:129], v[166:167]
    v_pk_fma_f32 v[168:169], v[146:147], v[128:129], v[168:169]
    v_pk_fma_f32 v[170:171], v[148:149], v[128:129], v[170:171]
    v_pk_fma_f32 v[156:157], v[132:133], v[130:131], v[156:157]
    v_pk_fma_f32 v[158:159], v[134:135], v[130:131], v[158:159]
    v_pk_fma_f32 v[160:161], v[136:137], v[130:131], v[160:161]
    v_pk_fma_f32 v[162:163], v[138:139], v[130:131], v[162:163]
    v_pk_fma_f32 v[164:165], v[140:141], v[130:131], v[164:165]
    v_pk_fma_f32 v[166:167], v[142:143], v[130:131], v[166:167]
    v_pk_fma_f32 v[168:169], v[144:145], v[130:131], v[168:169]
    v_pk_fma_f32 v[170:171], v[146:147], v[130:131], v[170:171]
    s_waitcnt lgkmcnt(0)
    v_lshlrev_b32 v140, 16, v116
    v_and_b32 v141, 0xffff0000, v116
    v_lshlrev_b32 v142, 16, v117
    v_and_b32 v143, 0xffff0000, v117
    v_lshlrev_b32 v144, 16, v118
    v_and_b32 v145, 0xffff0000, v118
    v_lshlrev_b32 v146, 16, v119
    v_and_b32 v147, 0xffff0000, v119
    v_lshlrev_b32 v148, 16, v120
    v_and_b32 v149, 0xffff0000, v120
    v_lshlrev_b32 v150, 16, v121
    v_and_b32 v151, 0xffff0000, v121
    v_lshlrev_b32 v152, 16, v122
    v_and_b32 v153, 0xffff0000, v122
    v_lshlrev_b32 v154, 16, v123
    v_and_b32 v155, 0xffff0000, v123
    v_pk_mul_f32 v[156:157], v[156:157], v[140:141]
    v_pk_mul_f32 v[158:159], v[158:159], v[142:143]
    v_pk_mul_f32 v[160:161], v[160:161], v[144:145]
    v_pk_mul_f32 v[162:163], v[162:163], v[146:147]
    v_pk_mul_f32 v[164:165], v[164:165], v[148:149]
    v_pk_mul_f32 v[166:167], v[166:167], v[150:151]
    v_pk_mul_f32 v[168:169], v[168:169], v[152:153]
    v_pk_mul_f32 v[170:171], v[170:171], v[154:155]
    v_cvt_pk_bf16_f32 v132, v170, v168
    v_cvt_pk_bf16_f32 v133, v166, v164
    v_cvt_pk_bf16_f32 v134, v162, v160
    v_cvt_pk_bf16_f32 v135, v158, v156
    ds_write_b128 v21, v[132:135] offset:0
    v_cvt_pk_bf16_f32 v136, v171, v169
    v_cvt_pk_bf16_f32 v137, v167, v165
    v_cvt_pk_bf16_f32 v138, v163, v161
    v_cvt_pk_bf16_f32 v139, v159, v157
    ds_write_b128 v21, v[136:139] offset:128
    s_add_u32 s61, s61, 1
    s_cmp_ge_u32 s61, s57
    s_cbranch_scc1 L_kv_done
    v_mov_b32 v172, v176
    v_mov_b32 v173, v177
    v_mov_b32 v174, v178
    v_mov_b32 v175, v179
    v_mov_b32 v176, v180
    v_mov_b32 v177, v181
    v_mov_b32 v178, v182
    v_mov_b32 v179, v183
    s_branch L_kv
L_kv_done:
    s_cmp_eq_u32 s57, 1
    s_waitcnt lgkmcnt(0)
    s_barrier
    s_cbranch_scc1 L_c_busy
    s_mul_i32 s68, s68, 1664525
    s_add_u32 s68, s68, 1013904223
    s_branch L_g1_done
L_c_busy:
    ds_read_b128 v[104:107], v4 offset:0
    ds_read_b128 v[108:111], v4 offset:2048
    ds_read_b64_tr_b16 v[112:113], v6 offset:0
    ds_read_b64_tr_b16 v[114:115], v6 offset:1024
    ds_read_b64_tr_b16 v[116:117], v7 offset:0
    ds_read_b64_tr_b16 v[118:119], v7 offset:1024
    ds_read_b64_tr_b16 v[120:121], v8 offset:0
    ds_read_b64_tr_b16 v[122:123], v8 offset:1024
    ds_read_b64_tr_b16 v[124:125], v9 offset:0
    ds_read_b64_tr_b16 v[126:127], v9 offset:1024
    ds_read_b64_tr_b16 v[128:129], v10 offset:0
    ds_read_b64_tr_b16 v[130:131], v10 offset:1024
    s_waitcnt lgkmcnt(4)
    ds_read_b64_tr_b16 v[132:133], v11 offset:0
    ds_read_b64_tr_b16 v[134:135], v11 offset:1024
    ds_read_b64_tr_b16 v[136:137], v12 offset:0
    ds_read_b64_tr_b16 v[138:139], v12 offset:1024
    ds_read_b64_tr_b16 v[140:141], v13 offset:0
    ds_read_b64_tr_b16 v[142:143], v13 offset:1024
    s_mul_i32 s68, s68, 1664525
    s_add_u32 s68, s68, 1013904223
    s_mov_b32 s61, 0
    s_mov_b32 s74, 1
    s_mov_b32 s62, 32768
    s_mov_b32 s65, 32768
    s_mov_b32 s64, -65536
L_g1:
    s_waitcnt lgkmcnt(12)
    v_mfma_f32_16x16x32_bf16 v[184:187], v[112:115], v[104:107], v[184:187]
    ds_read_b128 v[144:147], v5 offset:0
    ds_read_b128 v[148:151], v5 offset:2048
    v_mfma_f32_16x16x32_bf16 v[216:219], v[112:115], v[108:111], v[216:219]
    ds_read_b64_tr_b16 v[152:153], v6 offset:8192
    v_mfma_f32_16x16x32_bf16 v[188:191], v[116:119], v[104:107], v[188:191]
    ds_read_b64_tr_b16 v[154:155], v6 offset:9216
    v_mfma_f32_16x16x32_bf16 v[220:223], v[116:119], v[108:111], v[220:223]
    ds_read_b64_tr_b16 v[156:157], v7 offset:8192
    s_waitcnt lgkmcnt(13)
    v_mfma_f32_16x16x32_bf16 v[192:195], v[120:123], v[104:107], v[192:195]
    ds_read_b64_tr_b16 v[158:159], v7 offset:9216
    ds_read_b64_tr_b16 v[160:161], v8 offset:8192
    v_mfma_f32_16x16x32_bf16 v[224:227], v[120:123], v[108:111], v[224:227]
    ds_read_b64_tr_b16 v[162:163], v8 offset:9216
    v_mfma_f32_16x16x32_bf16 v[196:199], v[124:127], v[104:107], v[196:199]
    ds_read_b64_tr_b16 v[164:165], v9 offset:8192
    v_mfma_f32_16x16x32_bf16 v[228:231], v[124:127], v[108:111], v[228:231]
    ds_read_b64_tr_b16 v[166:167], v9 offset:9216
    s_waitcnt lgkmcnt(14)
    v_mfma_f32_16x16x32_bf16 v[200:203], v[128:131], v[104:107], v[200:203]
    ds_read_b64_tr_b16 v[168:169], v10 offset:8192
    ds_read_b64_tr_b16 v[170:171], v10 offset:9216
    v_mfma_f32_16x16x32_bf16 v[232:235], v[128:131], v[108:111], v[232:235]
    ds_read_b64_tr_b16 v[172:173], v11 offset:8192
    v_mfma_f32_16x16x32_bf16 v[204:207], v[132:135], v[104:107], v[204:207]
    ds_read_b64_tr_b16 v[174:175], v11 offset:9216
    v_mfma_f32_16x16x32_bf16 v[236:239], v[132:135], v[108:111], v[236:239]
    ds_read_b64_tr_b16 v[176:177], v12 offset:8192
    s_waitcnt lgkmcnt(14)
    v_mfma_f32_16x16x32_bf16 v[208:211], v[136:139], v[104:107], v[208:211]
    ds_read_b64_tr_b16 v[178:179], v12 offset:9216
    ds_read_b64_tr_b16 v[180:181], v13 offset:8192
    v_mfma_f32_16x16x32_bf16 v[240:243], v[136:139], v[108:111], v[240:243]
    ds_read_b64_tr_b16 v[182:183], v13 offset:9216
    v_mfma_f32_16x16x32_bf16 v[212:215], v[140:143], v[104:107], v[212:215]
    v_add_u32 v4, s62, v4
    v_add_u32 v5, s62, v5
    v_mfma_f32_16x16x32_bf16 v[244:247], v[140:143], v[108:111], v[244:247]
    v_add_u32 v6, s62, v6
    v_add_u32 v7, s62, v7
    v_mfma_f32_16x16x32_bf16 v[248:251], v[112:115], v[100:103], v[248:251]
    v_add_u32 v8, s62, v8
    v_add_u32 v9, s62, v9
    v_mfma_f32_16x16x32_bf16 v[252:255], v[116:119], v[100:103], v[252:255]
    v_add_u32 v10, s62, v10
    v_add_u32 v11, s62, v11
    s_waitcnt lgkmcnt(12)
    v_mfma_f32_16x16x32_bf16 v[184:187], v[152:155], v[144:147], v[184:187]
    v_add_u32 v12, s62, v12
    v_add_u32 v13, s62, v13
    v_mfma_f32_16x16x32_bf16 v[216:219], v[152:155], v[148:151], v[216:219]
    s_add_u32 s74, s74, 1
    s_cmp_eq_u32 s74, 3
    v_mfma_f32_16x16x32_bf16 v[188:191], v[156:159], v[144:147], v[188:191]
    s_cselect_b32 s74, 0, s74
    s_cselect_b32 s62, s64, s65
    s_cmp_ge_u32 s61, 9
    v_mfma_f32_16x16x32_bf16 v[220:223], v[156:159], v[148:151], v[220:223]
    s_waitcnt lgkmcnt(0)
    s_cbranch_scc1 L_g1_nobar
    s_barrier
L_g1_nobar:
    v_mfma_f32_16x16x32_bf16 v[192:195], v[160:163], v[144:147], v[192:195]
    ds_read_b128 v[104:107], v4 offset:0
    ds_read_b128 v[108:111], v4 offset:2048
    v_mfma_f32_16x16x32_bf16 v[224:227], v[160:163], v[148:151], v[224:227]
    ds_read_b64_tr_b16 v[112:113], v6 offset:0
    ds_read_b64_tr_b16 v[114:115], v6 offset:1024
    v_mfma_f32_16x16x32_bf16 v[196:199], v[164:167], v[144:147], v[196:199]
    ds_read_b64_tr_b16 v[116:117], v7 offset:0
    ds_read_b64_tr_b16 v[118:119], v7 offset:1024
    v_mfma_f32_16x16x32_bf16 v[228:231], v[164:167], v[148:151], v[228:231]
    ds_read_b64_tr_b16 v[120:121], v8 offset:0
    ds_read_b64_tr_b16 v[122:123], v8 offset:1024
    v_mfma_f32_16x16x32_bf16 v[200:203], v[168:171], v[144:147], v[200:203]
    ds_read_b64_tr_b16 v[124:125], v9 offset:0
    v_mfma_f32_16x16x32_bf16 v[232:235], v[168:171], v[148:151], v[232:235]
    ds_read_b64_tr_b16 v[126:127], v9 offset:1024
    v_mfma_f32_16x16x32_bf16 v[204:207], v[172:175], v[144:147], v[204:207]
    ds_read_b64_tr_b16 v[128:129], v10 offset:0
    v_mfma_f32_16x16x32_bf16 v[236:239], v[172:175], v[148:151], v[236:239]
    ds_read_b64_tr_b16 v[130:131], v10 offset:1024
    v_mfma_f32_16x16x32_bf16 v[208:211], v[176:179], v[144:147], v[208:211]
    ds_read_b64_tr_b16 v[132:133], v11 offset:0
    v_mfma_f32_16x16x32_bf16 v[240:243], v[176:179], v[148:151], v[240:243]
    ds_read_b64_tr_b16 v[134:135], v11 offset:1024
    v_mfma_f32_16x16x32_bf16 v[212:215], v[180:183], v[144:147], v[212:215]
    ds_read_b64_tr_b16 v[136:137], v12 offset:0
    v_mfma_f32_16x16x32_bf16 v[244:247], v[180:183], v[148:151], v[244:247]
    ds_read_b64_tr_b16 v[138:139], v12 offset:1024
    s_add_u32 s61, s61, 1
    v_mfma_f32_16x16x32_bf16 v[248:251], v[152:155], v[100:103], v[248:251]
    ds_read_b64_tr_b16 v[140:141], v13 offset:0
    s_cmp_lt_u32 s61, 10
    v_mfma_f32_16x16x32_bf16 v[252:255], v[156:159], v[100:103], v[252:255]
    ds_read_b64_tr_b16 v[142:143], v13 offset:1024
    s_cbranch_scc1 L_g1
L_g1_done:
    s_lshl_b32 s62, s52, 8
    s_add_u32 s62, s62, 162560
    v_lshl_add_u32 v17, v1, 3, s62
    ds_read_b64 v[56:57], v17
    ds_read_b64 v[58:59], v17 offset:128
    s_lshl_b32 s62, s52, 7
    s_add_u32 s63, s62, 162048
    v_add_u32 v17, s63, v0
    v_lshl_add_u32 v16, v2, 4, s62
    s_mov_b32 exec_lo, 0x10001
    s_mov_b32 exec_hi, 0x10001
    ds_write_b128 v17, v[248:251]
    ds_write_b128 v17, v[252:255] offset:64
    s_mov_b64 exec, -1
    v_mov_b32 v64, 0xc0135761
    v_mov_b32 v66, 0xbdd2d3e8
    v_mov_b32 v68, 1.0
    v_mov_b32 v65, 0xc0135761
    v_mov_b32 v67, 0xbdd2d3e8
    v_mov_b32 v69, 1.0
    s_lshl_b32 s62, s55, 1
    s_lshr_b32 s63, s52, 1
    s_add_u32 s62, s62, s63
    s_mul_i32 s62, s62, 221184
    s_and_b32 s63, s52, 1
    s_lshl_b32 s63, s63, 11
    s_add_u32 s62, s62, s63
    s_add_u32 s67, s62, 65536
    s_cmp_eq_u32 s57, 1
    s_cselect_b32 s67, s67, 1073741824
    s_lshl_b32 s70, s56, 2
    v_mov_b32 v18, 163584
    v_mov_b32 v19, 1
    s_waitcnt lgkmcnt(0)
    s_mov_b64 exec, 1
    ds_add_u32 v18, v19
    s_mov_b64 exec, -1
    v_mul_f32 v60, -v56, v57
    v_mul_f32 v62, -v58, v59
    v_mov_b32 v56, v57
    v_mov_b32 v58, v59
    v_mov_b32 v61, v60
    v_mov_b32 v63, v62
    s_waitcnt vmcnt(0)
    v_lshlrev_b32 v70, 16, v84
    v_and_b32 v71, 0xffff0000, v84
    v_lshlrev_b32 v72, 16, v85
    v_and_b32 v73, 0xffff0000, v85
    v_pk_fma_f32 v[74:75], v[248:249], v[60:61], v[70:71]
    v_pk_fma_f32 v[76:77], v[250:251], v[60:61], v[72:73]
    v_pk_fma_f32 v[184:185], v[184:185], v[56:57], v[74:75]
    v_pk_fma_f32 v[186:187], v[186:187], v[56:57], v[76:77]
    v_pk_mul_f32 v[74:75], v[184:185], v[184:185]
    v_pk_mul_f32 v[76:77], v[186:187], v[186:187]
    v_pk_fma_f32 v[74:75], v[74:75], v[66:67], v[64:65]
    v_pk_fma_f32 v[76:77], v[76:77], v[66:67], v[64:65]
    v_pk_mul_f32 v[74:75], v[74:75], v[184:185]
    v_pk_mul_f32 v[76:77], v[76:77], v[186:187]
    v_exp_f32 v74, v74
    v_exp_f32 v75, v75
    v_exp_f32 v76, v76
    v_exp_f32 v77, v77
    v_pk_add_f32 v[74:75], v[74:75], v[68:69]
    v_pk_add_f32 v[76:77], v[76:77], v[68:69]
    v_rcp_f32 v74, v74
    v_rcp_f32 v75, v75
    v_rcp_f32 v76, v76
    v_rcp_f32 v77, v77
    v_pk_mul_f32 v[184:185], v[184:185], v[74:75]
    v_pk_mul_f32 v[186:187], v[186:187], v[76:77]
    v_cvt_pk_bf16_f32 v104, v184, v185
    v_cvt_pk_bf16_f32 v105, v186, v187
    v_pk_fma_f32 v[74:75], v[248:249], v[62:63], v[70:71]
    v_pk_fma_f32 v[76:77], v[250:251], v[62:63], v[72:73]
    v_pk_fma_f32 v[216:217], v[216:217], v[58:59], v[74:75]
    v_pk_fma_f32 v[218:219], v[218:219], v[58:59], v[76:77]
    v_pk_mul_f32 v[74:75], v[216:217], v[216:217]
    v_pk_mul_f32 v[76:77], v[218:219], v[218:219]
    v_pk_fma_f32 v[74:75], v[74:75], v[66:67], v[64:65]
    v_pk_fma_f32 v[76:77], v[76:77], v[66:67], v[64:65]
    v_pk_mul_f32 v[74:75], v[74:75], v[216:217]
    v_pk_mul_f32 v[76:77], v[76:77], v[218:219]
    v_exp_f32 v74, v74
    v_exp_f32 v75, v75
    v_exp_f32 v76, v76
    v_exp_f32 v77, v77
    v_pk_add_f32 v[74:75], v[74:75], v[68:69]
    v_pk_add_f32 v[76:77], v[76:77], v[68:69]
    v_rcp_f32 v74, v74
    v_rcp_f32 v75, v75
    v_rcp_f32 v76, v76
    v_rcp_f32 v77, v77
    v_pk_mul_f32 v[216:217], v[216:217], v[74:75]
    v_pk_mul_f32 v[218:219], v[218:219], v[76:77]
    v_cvt_pk_bf16_f32 v120, v216, v217
    v_cvt_pk_bf16_f32 v121, v218, v219
    v_xor_b32 v9, 128, v16
    v_add_u32 v9, 162048, v9
    v_xor_b32 v10, 256, v16
    v_add_u32 v10, 162048, v10
    v_xor_b32 v11, 384, v16
    v_add_u32 v11, 162048, v11
    v_mov_b32 v18, 163584
    s_mov_b32 s69, 0
L_lwC:
    ds_read_b32 v19, v18
    s_add_u32 s69, s69, 1
    s_waitcnt lgkmcnt(0)
    v_readfirstlane_b32 s76, v19
    s_nop 0
    s_cmp_ge_u32 s76, 4
    s_cbranch_scc1 L_lwdC
    s_cmp_lt_u32 s69, 0x100000
    s_cbranch_scc1 L_lwC
L_lwdC:
    ds_read_b128 v[32:35], v9 offset:0
    ds_read_b128 v[36:39], v9 offset:64
    ds_read_b128 v[40:43], v10 offset:0
    ds_read_b128 v[44:47], v10 offset:64
    ds_read_b128 v[48:51], v11 offset:0
    ds_read_b128 v[52:55], v11 offset:64
    s_xor_b32 s63, s52, 0
    s_add_u32 s63, s63, s70
    s_lshl_b32 s64, s63, 12
    s_add_u32 s64, s64, s67
    s_cmp_lt_u32 s63, 54
    s_cselect_b32 s64, s64, 1073741824
    v_lshlrev_b32 v70, 16, v86
    v_and_b32 v71, 0xffff0000, v86
    v_lshlrev_b32 v72, 16, v87
    v_and_b32 v73, 0xffff0000, v87
    v_pk_fma_f32 v[74:75], v[252:253], v[60:61], v[70:71]
    v_pk_fma_f32 v[76:77], v[254:255], v[60:61], v[72:73]
    v_pk_fma_f32 v[188:189], v[188:189], v[56:57], v[74:75]
    v_pk_fma_f32 v[190:191], v[190:191], v[56:57], v[76:77]
    v_pk_mul_f32 v[74:75], v[188:189], v[188:189]
    v_pk_mul_f32 v[76:77], v[190:191], v[190:191]
    v_pk_fma_f32 v[74:75], v[74:75], v[66:67], v[64:65]
    v_pk_fma_f32 v[76:77], v[76:77], v[66:67], v[64:65]
    v_pk_mul_f32 v[74:75], v[74:75], v[188:189]
    v_pk_mul_f32 v[76:77], v[76:77], v[190:191]
    v_exp_f32 v74, v74
    v_exp_f32 v75, v75
    v_exp_f32 v76, v76
    v_exp_f32 v77, v77
    v_pk_add_f32 v[74:75], v[74:75], v[68:69]
    v_pk_add_f32 v[76:77], v[76:77], v[68:69]
    v_rcp_f32 v74, v74
    v_rcp_f32 v75, v75
    v_rcp_f32 v76, v76
    v_rcp_f32 v77, v77
    v_pk_mul_f32 v[188:189], v[188:189], v[74:75]
    v_pk_mul_f32 v[190:191], v[190:191], v[76:77]
    v_cvt_pk_bf16_f32 v106, v188, v189
    v_cvt_pk_bf16_f32 v107, v190, v191
    buffer_store_dwordx4 v[104:107], v3, s[48:51], s64 offen offset:0 sc0 sc1
    v_pk_fma_f32 v[74:75], v[252:253], v[62:63], v[70:71]
    v_pk_fma_f32 v[76:77], v[254:255], v[62:63], v[72:73]
    v_pk_fma_f32 v[220:221], v[220:221], v[58:59], v[74:75]
    v_pk_fma_f32 v[222:223], v[222:223], v[58:59], v[76:77]
    v_pk_mul_f32 v[74:75], v[220:221], v[220:221]
    v_pk_mul_f32 v[76:77], v[222:223], v[222:223]
    v_pk_fma_f32 v[74:75], v[74:75], v[66:67], v[64:65]
    v_pk_fma_f32 v[76:77], v[76:77], v[66:67], v[64:65]
    v_pk_mul_f32 v[74:75], v[74:75], v[220:221]
    v_pk_mul_f32 v[76:77], v[76:77], v[222:223]
    v_exp_f32 v74, v74
    v_exp_f32 v75, v75
    v_exp_f32 v76, v76
    v_exp_f32 v77, v77
    v_pk_add_f32 v[74:75], v[74:75], v[68:69]
    v_pk_add_f32 v[76:77], v[76:77], v[68:69]
    v_rcp_f32 v74, v74
    v_rcp_f32 v75, v75
    v_rcp_f32 v76, v76
    v_rcp_f32 v77, v77
    v_pk_mul_f32 v[220:221], v[220:221], v[74:75]
    v_pk_mul_f32 v[222:223], v[222:223], v[76:77]
    v_cvt_pk_bf16_f32 v122, v220, v221
    v_cvt_pk_bf16_f32 v123, v222, v223
    buffer_store_dwordx4 v[120:123], v3, s[48:51], s64 offen offset:1024 sc0 sc1
    s_waitcnt lgkmcnt(0)
    v_lshlrev_b32 v70, 16, v88
    v_and_b32 v71, 0xffff0000, v88
    v_lshlrev_b32 v72, 16, v89
    v_and_b32 v73, 0xffff0000, v89
    v_pk_fma_f32 v[74:75], v[32:33], v[60:61], v[70:71]
    v_pk_fma_f32 v[76:77], v[34:35], v[60:61], v[72:73]
    v_pk_fma_f32 v[192:193], v[192:193], v[56:57], v[74:75]
    v_pk_fma_f32 v[194:195], v[194:195], v[56:57], v[76:77]
    v_pk_mul_f32 v[74:75], v[192:193], v[192:193]
    v_pk_mul_f32 v[76:77], v[194:195], v[194:195]
    v_pk_fma_f32 v[74:75], v[74:75], v[66:67], v[64:65]
    v_pk_fma_f32 v[76:77], v[76:77], v[66:67], v[64:65]
    v_pk_mul_f32 v[74:75], v[74:75], v[192:193]
    v_pk_mul_f32 v[76:77], v[76:77], v[194:195]
    v_exp_f32 v74, v74
    v_exp_f32 v75, v75
    v_exp_f32 v76, v76
    v_exp_f32 v77, v77
    v_pk_add_f32 v[74:75], v[74:75], v[68:69]
    v_pk_add_f32 v[76:77], v[76:77], v[68:69]
    v_rcp_f32 v74, v74
    v_rcp_f32 v75, v75
    v_rcp_f32 v76, v76
    v_rcp_f32 v77, v77
    v_pk_mul_f32 v[192:193], v[192:193], v[74:75]
    v_pk_mul_f32 v[194:195], v[194:195], v[76:77]
    v_cvt_pk_bf16_f32 v108, v192, v193
    v_cvt_pk_bf16_f32 v109, v194, v195
    v_pk_fma_f32 v[74:75], v[32:33], v[62:63], v[70:71]
    v_pk_fma_f32 v[76:77], v[34:35], v[62:63], v[72:73]
    v_pk_fma_f32 v[224:225], v[224:225], v[58:59], v[74:75]
    v_pk_fma_f32 v[226:227], v[226:227], v[58:59], v[76:77]
    v_pk_mul_f32 v[74:75], v[224:225], v[224:225]
    v_pk_mul_f32 v[76:77], v[226:227], v[226:227]
    v_pk_fma_f32 v[74:75], v[74:75], v[66:67], v[64:65]
    v_pk_fma_f32 v[76:77], v[76:77], v[66:67], v[64:65]
    v_pk_mul_f32 v[74:75], v[74:75], v[224:225]
    v_pk_mul_f32 v[76:77], v[76:77], v[226:227]
    v_exp_f32 v74, v74
    v_exp_f32 v75, v75
    v_exp_f32 v76, v76
    v_exp_f32 v77, v77
    v_pk_add_f32 v[74:75], v[74:75], v[68:69]
    v_pk_add_f32 v[76:77], v[76:77], v[68:69]
    v_rcp_f32 v74, v74
    v_rcp_f32 v75, v75
    v_rcp_f32 v76, v76
    v_rcp_f32 v77, v77
    v_pk_mul_f32 v[224:225], v[224:225], v[74:75]
    v_pk_mul_f32 v[226:227], v[226:227], v[76:77]
    v_cvt_pk_bf16_f32 v124, v224, v225
    v_cvt_pk_bf16_f32 v125, v226, v227
    s_xor_b32 s63, s52, 1
    s_add_u32 s63, s63, s70
    s_lshl_b32 s64, s63, 12
    s_add_u32 s64, s64, s67
    s_cmp_lt_u32 s63, 54
    s_cselect_b32 s64, s64, 1073741824
    v_lshlrev_b32 v70, 16, v90
    v_and_b32 v71, 0xffff0000, v90
    v_lshlrev_b32 v72, 16, v91
    v_and_b32 v73, 0xffff0000, v91
    v_pk_fma_f32 v[74:75], v[36:37], v[60:61], v[70:71]
    v_pk_fma_f32 v[76:77], v[38:39], v[60:61], v[72:73]
    v_pk_fma_f32 v[196:197], v[196:197], v[56:57], v[74:75]
    v_pk_fma_f32 v[198:199], v[198:199], v[56:57], v[76:77]
    v_pk_mul_f32 v[74:75], v[196:197], v[196:197]
    v_pk_mul_f32 v[76:77], v[198:199], v[198:199]
    v_pk_fma_f32 v[74:75], v[74:75], v[66:67], v[64:65]
    v_pk_fma_f32 v[76:77], v[76:77], v[66:67], v[64:65]
    v_pk_mul_f32 v[74:75], v[74:75], v[196:197]
    v_pk_mul_f32 v[76:77], v[76:77], v[198:199]
    v_exp_f32 v74, v74
    v_exp_f32 v75, v75
    v_exp_f32 v76, v76
    v_exp_f32 v77, v77
    v_pk_add_f32 v[74:75], v[74:75], v[68:69]
    v_pk_add_f32 v[76:77], v[76:77], v[68:69]
    v_rcp_f32 v74, v74
    v_rcp_f32 v75, v75
    v_rcp_f32 v76, v76
    v_rcp_f32 v77, v77
    v_pk_mul_f32 v[196:197], v[196:197], v[74:75]
    v_pk_mul_f32 v[198:199], v[198:199], v[76:77]
    v_cvt_pk_bf16_f32 v110, v196, v197
    v_cvt_pk_bf16_f32 v111, v198, v199
    buffer_store_dwordx4 v[108:111], v3, s[48:51], s64 offen offset:0 sc0 sc1
    v_pk_fma_f32 v[74:75], v[36:37], v[62:63], v[70:71]
    v_pk_fma_f32 v[76:77], v[38:39], v[62:63], v[72:73]
    v_pk_fma_f32 v[228:229], v[228:229], v[58:59], v[74:75]
    v_pk_fma_f32 v[230:231], v[230:231], v[58:59], v[76:77]
    v_pk_mul_f32 v[74:75], v[228:229], v[228:229]
    v_pk_mul_f32 v[76:77], v[230:231], v[230:231]
    v_pk_fma_f32 v[74:75], v[74:75], v[66:67], v[64:65]
    v_pk_fma_f32 v[76:77], v[76:77], v[66:67], v[64:65]
    v_pk_mul_f32 v[74:75], v[74:75], v[228:229]
    v_pk_mul_f32 v[76:77], v[76:77], v[230:231]
    v_exp_f32 v74, v74
    v_exp_f32 v75, v75
    v_exp_f32 v76, v76
    v_exp_f32 v77, v77
    v_pk_add_f32 v[74:75], v[74:75], v[68:69]
    v_pk_add_f32 v[76:77], v[76:77], v[68:69]
    v_rcp_f32 v74, v74
    v_rcp_f32 v75, v75
    v_rcp_f32 v76, v76
    v_rcp_f32 v77, v77
    v_pk_mul_f32 v[228:229], v[228:229], v[74:75]
    v_pk_mul_f32 v[230:231], v[230:231], v[76:77]
    v_cvt_pk_bf16_f32 v126, v228, v229
    v_cvt_pk_bf16_f32 v127, v230, v231
    buffer_store_dwordx4 v[124:127], v3, s[48:51], s64 offen offset:1024 sc0 sc1
    v_lshlrev_b32 v70, 16, v92
    v_and_b32 v71, 0xffff0000, v92
    v_lshlrev_b32 v72, 16, v93
    v_and_b32 v73, 0xffff0000, v93
    v_pk_fma_f32 v[74:75], v[40:41], v[60:61], v[70:71]
    v_pk_fma_f32 v[76:77], v[42:43], v[60:61], v[72:73]
    v_pk_fma_f32 v[200:201], v[200:201], v[56:57], v[74:75]
    v_pk_fma_f32 v[202:203], v[202:203], v[56:57], v[76:77]
    v_pk_mul_f32 v[74:75], v[200:201], v[200:201]
    v_pk_mul_f32 v[76:77], v[202:203], v[202:203]
    v_pk_fma_f32 v[74:75], v[74:75], v[66:67], v[64:65]
    v_pk_fma_f32 v[76:77], v[76:77], v[66:67], v[64:65]
    v_pk_mul_f32 v[74:75], v[74:75], v[200:201]
    v_pk_mul_f32 v[76:77], v[76:77], v[202:203]
    v_exp_f32 v74, v74
    v_exp_f32 v75, v75
    v_exp_f32 v76, v76
    v_exp_f32 v77, v77
    v_pk_add_f32 v[74:75], v[74:75], v[68:69]
    v_pk_add_f32 v[76:77], v[76:77], v[68:69]
    v_rcp_f32 v74, v74
    v_rcp_f32 v75, v75
    v_rcp_f32 v76, v76
    v_rcp_f32 v77, v77
    v_pk_mul_f32 v[200:201], v[200:201], v[74:75]
    v_pk_mul_f32 v[202:203], v[202:203], v[76:77]
    v_cvt_pk_bf16_f32 v112, v200, v201
    v_cvt_pk_bf16_f32 v113, v202, v203
    v_pk_fma_f32 v[74:75], v[40:41], v[62:63], v[70:71]
    v_pk_fma_f32 v[76:77], v[42:43], v[62:63], v[72:73]
    v_pk_fma_f32 v[232:233], v[232:233], v[58:59], v[74:75]
    v_pk_fma_f32 v[234:235], v[234:235], v[58:59], v[76:77]
    v_pk_mul_f32 v[74:75], v[232:233], v[232:233]
    v_pk_mul_f32 v[76:77], v[234:235], v[234:235]
    v_pk_fma_f32 v[74:75], v[74:75], v[66:67], v[64:65]
    v_pk_fma_f32 v[76:77], v[76:77], v[66:67], v[64:65]
    v_pk_mul_f32 v[74:75], v[74:75], v[232:233]
    v_pk_mul_f32 v[76:77], v[76:77], v[234:235]
    v_exp_f32 v74, v74
    v_exp_f32 v75, v75
    v_exp_f32 v76, v76
    v_exp_f32 v77, v77
    v_pk_add_f32 v[74:75], v[74:75], v[68:69]
    v_pk_add_f32 v[76:77], v[76:77], v[68:69]
    v_rcp_f32 v74, v74
    v_rcp_f32 v75, v75
    v_rcp_f32 v76, v76
    v_rcp_f32 v77, v77
    v_pk_mul_f32 v[232:233], v[232:233], v[74:75]
    v_pk_mul_f32 v[234:235], v[234:235], v[76:77]
    v_cvt_pk_bf16_f32 v128, v232, v233
    v_cvt_pk_bf16_f32 v129, v234, v235
    s_xor_b32 s63, s52, 2
    s_add_u32 s63, s63, s70
    s_lshl_b32 s64, s63, 12
    s_add_u32 s64, s64, s67
    s_cmp_lt_u32 s63, 54
    s_cselect_b32 s64, s64, 1073741824
    v_lshlrev_b32 v70, 16, v94
    v_and_b32 v71, 0xffff0000, v94
    v_lshlrev_b32 v72, 16, v95
    v_and_b32 v73, 0xffff0000, v95
    v_pk_fma_f32 v[74:75], v[44:45], v[60:61], v[70:71]
    v_pk_fma_f32 v[76:77], v[46:47], v[60:61], v[72:73]
    v_pk_fma_f32 v[204:205], v[204:205], v[56:57], v[74:75]
    v_pk_fma_f32 v[206:207], v[206:207], v[56:57], v[76:77]
    v_pk_mul_f32 v[74:75], v[204:205], v[204:205]
    v_pk_mul_f32 v[76:77], v[206:207], v[206:207]
    v_pk_fma_f32 v[74:75], v[74:75], v[66:67], v[64:65]
    v_pk_fma_f32 v[76:77], v[76:77], v[66:67], v[64:65]
    v_pk_mul_f32 v[74:75], v[74:75], v[204:205]
    v_pk_mul_f32 v[76:77], v[76:77], v[206:207]
    v_exp_f32 v74, v74
    v_exp_f32 v75, v75
    v_exp_f32 v76, v76
    v_exp_f32 v77, v77
    v_pk_add_f32 v[74:75], v[74:75], v[68:69]
    v_pk_add_f32 v[76:77], v[76:77], v[68:69]
    v_rcp_f32 v74, v74
    v_rcp_f32 v75, v75
    v_rcp_f32 v76, v76
    v_rcp_f32 v77, v77
    v_pk_mul_f32 v[204:205], v[204:205], v[74:75]
    v_pk_mul_f32 v[206:207], v[206:207], v[76:77]
    v_cvt_pk_bf16_f32 v114, v204, v205
    v_cvt_pk_bf16_f32 v115, v206, v207
    buffer_store_dwordx4 v[112:115], v3, s[48:51], s64 offen offset:0 sc0 sc1
    v_pk_fma_f32 v[74:75], v[44:45], v[62:63], v[70:71]
    v_pk_fma_f32 v[76:77], v[46:47], v[62:63], v[72:73]
    v_pk_fma_f32 v[236:237], v[236:237], v[58:59], v[74:75]
    v_pk_fma_f32 v[238:239], v[238:239], v[58:59], v[76:77]
    v_pk_mul_f32 v[74:75], v[236:237], v[236:237]
    v_pk_mul_f32 v[76:77], v[238:239], v[238:239]
    v_pk_fma_f32 v[74:75], v[74:75], v[66:67], v[64:65]
    v_pk_fma_f32 v[76:77], v[76:77], v[66:67], v[64:65]
    v_pk_mul_f32 v[74:75], v[74:75], v[236:237]
    v_pk_mul_f32 v[76:77], v[76:77], v[238:239]
    v_exp_f32 v74, v74
    v_exp_f32 v75, v75
    v_exp_f32 v76, v76
    v_exp_f32 v77, v77
    v_pk_add_f32 v[74:75], v[74:75], v[68:69]
    v_pk_add_f32 v[76:77], v[76:77], v[68:69]
    v_rcp_f32 v74, v74
    v_rcp_f32 v75, v75
    v_rcp_f32 v76, v76
    v_rcp_f32 v77, v77
    v_pk_mul_f32 v[236:237], v[236:237], v[74:75]
    v_pk_mul_f32 v[238:239], v[238:239], v[76:77]
    v_cvt_pk_bf16_f32 v130, v236, v237
    v_cvt_pk_bf16_f32 v131, v238, v239
    buffer_store_dwordx4 v[128:131], v3, s[48:51], s64 offen offset:1024 sc0 sc1
    v_lshlrev_b32 v70, 16, v96
    v_and_b32 v71, 0xffff0000, v96
    v_lshlrev_b32 v72, 16, v97
    v_and_b32 v73, 0xffff0000, v97
    v_pk_fma_f32 v[74:75], v[48:49], v[60:61], v[70:71]
    v_pk_fma_f32 v[76:77], v[50:51], v[60:61], v[72:73]
    v_pk_fma_f32 v[208:209], v[208:209], v[56:57], v[74:75]
    v_pk_fma_f32 v[210:211], v[210:211], v[56:57], v[76:77]
    v_pk_mul_f32 v[74:75], v[208:209], v[208:209]
    v_pk_mul_f32 v[76:77], v[210:211], v[210:211]
    v_pk_fma_f32 v[74:75], v[74:75], v[66:67], v[64:65]
    v_pk_fma_f32 v[76:77], v[76:77], v[66:67], v[64:65]
    v_pk_mul_f32 v[74:75], v[74:75], v[208:209]
    v_pk_mul_f32 v[76:77], v[76:77], v[210:211]
    v_exp_f32 v74, v74
    v_exp_f32 v75, v75
    v_exp_f32 v76, v76
    v_exp_f32 v77, v77
    v_pk_add_f32 v[74:75], v[74:75], v[68:69]
    v_pk_add_f32 v[76:77], v[76:77], v[68:69]
    v_rcp_f32 v74, v74
    v_rcp_f32 v75, v75
    v_rcp_f32 v76, v76
    v_rcp_f32 v77, v77
    v_pk_mul_f32 v[208:209], v[208:209], v[74:75]
    v_pk_mul_f32 v[210:211], v[210:211], v[76:77]
    v_cvt_pk_bf16_f32 v116, v208, v209
    v_cvt_pk_bf16_f32 v117, v210, v211
    v_pk_fma_f32 v[74:75], v[48:49], v[62:63], v[70:71]
    v_pk_fma_f32 v[76:77], v[50:51], v[62:63], v[72:73]
    v_pk_fma_f32 v[240:241], v[240:241], v[58:59], v[74:75]
    v_pk_fma_f32 v[242:243], v[242:243], v[58:59], v[76:77]
    v_pk_mul_f32 v[74:75], v[240:241], v[240:241]
    v_pk_mul_f32 v[76:77], v[242:243], v[242:243]
    v_pk_fma_f32 v[74:75], v[74:75], v[66:67], v[64:65]
    v_pk_fma_f32 v[76:77], v[76:77], v[66:67], v[64:65]
    v_pk_mul_f32 v[74:75], v[74:75], v[240:241]
    v_pk_mul_f32 v[76:77], v[76:77], v[242:243]
    v_exp_f32 v74, v74
    v_exp_f32 v75, v75
    v_exp_f32 v76, v76
    v_exp_f32 v77, v77
    v_pk_add_f32 v[74:75], v[74:75], v[68:69]
    v_pk_add_f32 v[76:77], v[76:77], v[68:69]
    v_rcp_f32 v74, v74
    v_rcp_f32 v75, v75
    v_rcp_f32 v76, v76
    v_rcp_f32 v77, v77
    v_pk_mul_f32 v[240:241], v[240:241], v[74:75]
    v_pk_mul_f32 v[242:243], v[242:243], v[76:77]
    v_cvt_pk_bf16_f32 v132, v240, v241
    v_cvt_pk_bf16_f32 v133, v242, v243
    s_xor_b32 s63, s52, 3
    s_add_u32 s63, s63, s70
    s_lshl_b32 s64, s63, 12
    s_add_u32 s64, s64, s67
    s_cmp_lt_u32 s63, 54
    s_cselect_b32 s64, s64, 1073741824
    v_lshlrev_b32 v70, 16, v98
    v_and_b32 v71, 0xffff0000, v98
    v_lshlrev_b32 v72, 16, v99
    v_and_b32 v73, 0xffff0000, v99
    v_pk_fma_f32 v[74:75], v[52:53], v[60:61], v[70:71]
    v_pk_fma_f32 v[76:77], v[54:55], v[60:61], v[72:73]
    v_pk_fma_f32 v[212:213], v[212:213], v[56:57], v[74:75]
    v_pk_fma_f32 v[214:215], v[214:215], v[56:57], v[76:77]
    v_pk_mul_f32 v[74:75], v[212:213], v[212:213]
    v_pk_mul_f32 v[76:77], v[214:215], v[214:215]
    v_pk_fma_f32 v[74:75], v[74:75], v[66:67], v[64:65]
    v_pk_fma_f32 v[76:77], v[76:77], v[66:67], v[64:65]
    v_pk_mul_f32 v[74:75], v[74:75], v[212:213]
    v_pk_mul_f32 v[76:77], v[76:77], v[214:215]
    v_exp_f32 v74, v74
    v_exp_f32 v75, v75
    v_exp_f32 v76, v76
    v_exp_f32 v77, v77
    v_pk_add_f32 v[74:75], v[74:75], v[68:69]
    v_pk_add_f32 v[76:77], v[76:77], v[68:69]
    v_rcp_f32 v74, v74
    v_rcp_f32 v75, v75
    v_rcp_f32 v76, v76
    v_rcp_f32 v77, v77
    v_pk_mul_f32 v[212:213], v[212:213], v[74:75]
    v_pk_mul_f32 v[214:215], v[214:215], v[76:77]
    v_cvt_pk_bf16_f32 v118, v212, v213
    v_cvt_pk_bf16_f32 v119, v214, v215
    buffer_store_dwordx4 v[116:119], v3, s[48:51], s64 offen offset:0 sc0 sc1
    v_pk_fma_f32 v[74:75], v[52:53], v[62:63], v[70:71]
    v_pk_fma_f32 v[76:77], v[54:55], v[62:63], v[72:73]
    v_pk_fma_f32 v[244:245], v[244:245], v[58:59], v[74:75]
    v_pk_fma_f32 v[246:247], v[246:247], v[58:59], v[76:77]
    v_pk_mul_f32 v[74:75], v[244:245], v[244:245]
    v_pk_mul_f32 v[76:77], v[246:247], v[246:247]
    v_pk_fma_f32 v[74:75], v[74:75], v[66:67], v[64:65]
    v_pk_fma_f32 v[76:77], v[76:77], v[66:67], v[64:65]
    v_pk_mul_f32 v[74:75], v[74:75], v[244:245]
    v_pk_mul_f32 v[76:77], v[76:77], v[246:247]
    v_exp_f32 v74, v74
    v_exp_f32 v75, v75
    v_exp_f32 v76, v76
    v_exp_f32 v77, v77
    v_pk_add_f32 v[74:75], v[74:75], v[68:69]
    v_pk_add_f32 v[76:77], v[76:77], v[68:69]
    v_rcp_f32 v74, v74
    v_rcp_f32 v75, v75
    v_rcp_f32 v76, v76
    v_rcp_f32 v77, v77
    v_pk_mul_f32 v[244:245], v[244:245], v[74:75]
    v_pk_mul_f32 v[246:247], v[246:247], v[76:77]
    v_cvt_pk_bf16_f32 v134, v244, v245
    v_cvt_pk_bf16_f32 v135, v246, v247
    buffer_store_dwordx4 v[132:135], v3, s[48:51], s64 offen offset:1024 sc0 sc1
    s_lshl_b32 s76, s52, 2
    s_add_u32 s76, s76, 163616
    v_mov_b32 v18, s76
    v_mov_b32 v19, 1
    s_mov_b64 exec, 1
    ds_add_u32 v18, v19
    s_mov_b64 exec, -1
L_g2_pro:
    s_setprio 0
    s_sub_u32 s70, 3, s52
    s_mul_i32 s62, s60, 54
    s_add_u32 s62, s62, s70
    s_mul_i32 s72, s62, 5120
    s_add_u32 s72, s72, 7340032
    v_add_u32 v4, 4096, v3
    s_lshl_b32 s62, s55, 4
    s_add_u32 s62, s62, s56
    s_lshl_b32 s62, s62, 2
    s_add_u32 s62, s62, s52
    s_lshl_b32 s62, s62, 7
    s_add_u32 s62, s62, 17498112
    s_cmp_eq_u32 s57, 1
    s_cselect_b32 s62, s62, 1073741824
    s_lshr_b32 s74, s59, 1
    s_lshl_b32 s74, s74, 13
    s_and_b32 s63, s59, 1
    s_lshl_b32 s63, s63, 8
    s_add_u32 s74, s74, s63
    s_add_u32 s74, s74, 17498112
    v_min_u32 v13, 27, v0
    v_lshrrev_b32 v15, 1, v13
    v_and_b32 v13, 1, v13
    v_lshlrev_b32 v13, 7, v13
    v_lshl_add_u32 v13, v15, 9, v13
    s_waitcnt vmcnt(0)
    v_mov_b32 v19, s68
    s_mov_b64 exec, 1
    buffer_store_dword v19, off, s[48:51], s62 sc0 sc1
    s_mov_b64 exec, -1
    v_mov_b32 v18, 163648
    v_mov_b32 v19, 1
    s_mov_b64 exec, 1
    ds_add_u32 v18, v19
    s_mov_b64 exec, -1
    v_mov_b32 v18, 163648
    s_mov_b32 s69, 0
L_lwF:
    ds_read_b32 v19, v18
    s_add_u32 s69, s69, 1
    s_waitcnt lgkmcnt(0)
    v_readfirstlane_b32 s76, v19
    s_nop 0
    s_cmp_ge_u32 s76, 4
    s_cbranch_scc1 L_lwdF
    s_cmp_lt_u32 s69, 0x100000
    s_cbranch_scc1 L_lwF
L_lwdF:
    v_mov_b32 v18, 163600
    s_mov_b32 s69, 0
L_lwA:
    ds_read_b32 v19, v18
    s_add_u32 s69, s69, 1
    s_waitcnt lgkmcnt(0)
    v_readfirstlane_b32 s76, v19
    s_nop 0
    s_cmp_ge_u32 s76, 1
    s_cbranch_scc1 L_lwdA
    s_sleep 1
    s_cmp_lt_u32 s69, 0x100000
    s_cbranch_scc1 L_lwA
L_lwdA:
    buffer_load_dwordx4 v[148:151], v3, s[48:51], s72 offen offset:0 sc1
    buffer_load_dwordx4 v[152:155], v3, s[48:51], s72 offen offset:1024 sc1
    buffer_load_dwordx4 v[156:159], v3, s[48:51], s72 offen offset:2048 sc1
    buffer_load_dwordx4 v[160:163], v3, s[48:51], s72 offen offset:3072 sc1
    buffer_load_dwordx4 v[164:167], v4, s[48:51], s72 offen offset:0 sc1
    s_add_u32 s72, s72, 20480
    buffer_load_dwordx4 v[168:171], v3, s[48:51], s72 offen offset:0 sc1
    buffer_load_dwordx4 v[172:175], v3, s[48:51], s72 offen offset:1024 sc1
    buffer_load_dwordx4 v[176:179], v3, s[48:51], s72 offen offset:2048 sc1
    buffer_load_dwordx4 v[180:183], v3, s[48:51], s72 offen offset:3072 sc1
    buffer_load_dwordx4 v[184:187], v4, s[48:51], s72 offen offset:0 sc1
    s_add_u32 s72, s72, 20480
    buffer_load_dwordx4 v[188:191], v3, s[48:51], s72 offen offset:0 sc1
    buffer_load_dwordx4 v[192:195], v3, s[48:51], s72 offen offset:1024 sc1
    buffer_load_dwordx4 v[196:199], v3, s[48:51], s72 offen offset:2048 sc1
    buffer_load_dwordx4 v[200:203], v3, s[48:51], s72 offen offset:3072 sc1
    buffer_load_dwordx4 v[204:207], v4, s[48:51], s72 offen offset:0 sc1
    s_add_u32 s72, s72, 20480
    buffer_load_dwordx4 v[208:211], v3, s[48:51], s72 offen offset:0 sc1
    buffer_load_dwordx4 v[212:215], v3, s[48:51], s72 offen offset:1024 sc1
    buffer_load_dwordx4 v[216:219], v3, s[48:51], s72 offen offset:2048 sc1
    buffer_load_dwordx4 v[220:223], v3, s[48:51], s72 offen offset:3072 sc1
    buffer_load_dwordx4 v[224:227], v4, s[48:51], s72 offen offset:0 sc1
    s_add_u32 s72, s72, 20480
    buffer_load_dwordx4 v[228:231], v3, s[48:51], s72 offen offset:0 sc1
    buffer_load_dwordx4 v[232:235], v3, s[48:51], s72 offen offset:1024 sc1
    buffer_load_dwordx4 v[236:239], v3, s[48:51], s72 offen offset:2048 sc1
    buffer_load_dwordx4 v[240:243], v3, s[48:51], s72 offen offset:3072 sc1
    buffer_load_dwordx4 v[244:247], v4, s[48:51], s72 offen offset:0 sc1
    s_add_u32 s72, s72, 102400
    s_cmp_eq_u32 s57, 1
    s_cbranch_scc1 L_nowt3
    s_mul_i32 s63, s60, 54
    s_add_u32 s63, s63, s70
    s_add_u32 s63, s63, 20
    s_mul_i32 s63, s63, 5120
    s_add_u32 s63, s63, 7340032
    v_min_u32 v15, 39, v0
    v_lshlrev_b32 v15, 7, v15
    buffer_load_dword v16, v15, s[48:51], s63 offen sc1
    s_add_u32 s63, s63, 20480
    buffer_load_dword v16, v15, s[48:51], s63 offen sc1
    s_add_u32 s63, s63, 20480
    buffer_load_dword v16, v15, s[48:51], s63 offen sc1
    s_add_u32 s63, s63, 20480
    buffer_load_dword v16, v15, s[48:51], s63 offen sc1
    s_add_u32 s63, s63, 20480
    s_waitcnt vmcnt(0)
L_nowt3:
    s_mul_i32 s63, s59, 54
    s_add_u32 s63, s63, s70
    s_lshl_b32 s67, s63, 12
    s_add_u32 s67, s67, 65536
    s_mul_i32 s63, s52, 20480
    v_add_u32 v7, s63, v3
    s_lshl_b32 s64, s59, 6
    s_lshl_b32 s63, s52, 4
    s_add_u32 s64, s64, s63
    s_mul_i32 s64, s64, 1280
    s_mul_i32 s56, s60, 160
    s_add_u32 s56, s56, s64
    v_add_u32 v17, 0, v0
    v_mul_u32_u24 v15, 6554, v17
    v_lshrrev_b32 v15, 16, v15
    v_mul_u32_u24 v16, 10, v15
    v_sub_u32 v16, v17, v16
    v_mul_u32_u24 v15, 1280, v15
    v_lshl_add_u32 v5, v16, 4, v15
    v_add_u32 v17, 64, v0
    v_mul_u32_u24 v15, 6554, v17
    v_lshrrev_b32 v15, 16, v15
    v_mul_u32_u24 v16, 10, v15
    v_sub_u32 v16, v17, v16
    v_mul_u32_u24 v15, 1280, v15
    v_lshl_add_u32 v6, v16, 4, v15
    v_add_u32 v17, 128, v0
    v_mul_u32_u24 v15, 6554, v17
    v_lshrrev_b32 v15, 16, v15
    v_mul_u32_u24 v16, 10, v15
    v_sub_u32 v16, v17, v16
    v_mul_u32_u24 v15, 1280, v15
    v_lshl_add_u32 v12, v16, 4, v15
    s_xor_b32 s63, s52, 0
    s_lshl_b32 s63, s63, 10
    v_add_u32 v8, s63, v3
    s_xor_b32 s63, s52, 1
    s_lshl_b32 s63, s63, 10
    v_add_u32 v9, s63, v3
    s_xor_b32 s63, s52, 2
    s_lshl_b32 s63, s63, 10
    v_add_u32 v10, s63, v3
    s_xor_b32 s63, s52, 3
    s_lshl_b32 s63, s63, 10
    v_add_u32 v11, s63, v3
    s_cmp_eq_u32 s52, 0
    s_cbranch_scc0 L_hwait
    s_mov_b32 s69, 0
L_pollH:
    buffer_load_dword v16, v13, s[48:51], s74 offen sc1
    s_waitcnt vmcnt(0)
    v_cmp_eq_u32 vcc, s68, v16
    s_nop 0
    s_cmp_eq_u64 vcc, -1
    s_cbranch_scc1 L_polldH
    s_sleep 2
    s_add_u32 s69, s69, 1
    s_cmp_lt_u32 s69, 0x8000
    s_cbranch_scc1 L_pollH
L_polldH:
    v_mov_b32 v18, 163612
    v_mov_b32 v19, 1
    s_mov_b64 exec, 1
    ds_add_u32 v18, v19
    s_mov_b64 exec, -1
    s_branch L_hready
L_hwait:
    v_mov_b32 v18, 163612
    s_mov_b32 s69, 0
L_lwHC:
    ds_read_b32 v19, v18
    s_add_u32 s69, s69, 1
    s_waitcnt lgkmcnt(0)
    v_readfirstlane_b32 s76, v19
    s_nop 0
    s_cmp_ge_u32 s76, 1
    s_cbranch_scc1 L_lwdHC
    s_sleep 1
    s_cmp_lt_u32 s69, 0x100000
    s_cbranch_scc1 L_lwHC
L_lwdHC:
L_hready:
    buffer_load_dwordx4 v[100:103], v8, s[48:51], s67 offen sc1
    buffer_load_dwordx4 v[104:107], v9, s[48:51], s67 offen sc1
    buffer_load_dwordx4 v[108:111], v10, s[48:51], s67 offen sc1
    buffer_load_dwordx4 v[112:115], v11, s[48:51], s67 offen sc1
    s_add_u32 s67, s67, 16384
    buffer_load_dwordx4 v[116:119], v8, s[48:51], s67 offen sc1
    buffer_load_dwordx4 v[120:123], v9, s[48:51], s67 offen sc1
    buffer_load_dwordx4 v[124:127], v10, s[48:51], s67 offen sc1
    buffer_load_dwordx4 v[128:131], v11, s[48:51], s67 offen sc1
    s_add_u32 s67, s67, 16384
    buffer_load_dwordx4 v[132:135], v8, s[48:51], s67 offen sc1
    buffer_load_dwordx4 v[136:139], v9, s[48:51], s67 offen sc1
    buffer_load_dwordx4 v[140:143], v10, s[48:51], s67 offen sc1
    buffer_load_dwordx4 v[144:147], v11, s[48:51], s67 offen sc1
    s_add_u32 s67, s67, 16384
    s_waitcnt vmcnt(8)
    v_mfma_f32_16x16x32_bf16 v[20:23], v[148:151], v[100:103], 0
    v_mfma_f32_16x16x32_bf16 v[24:27], v[152:155], v[100:103], 0
    v_mfma_f32_16x16x32_bf16 v[28:31], v[156:159], v[100:103], 0
    v_mfma_f32_16x16x32_bf16 v[32:35], v[160:163], v[100:103], 0
    v_mfma_f32_16x16x32_bf16 v[36:39], v[164:167], v[100:103], 0
    v_mfma_f32_16x16x32_bf16 v[40:43], v[148:151], v[104:107], 0
    buffer_load_dwordx4 v[100:103], v8, s[48:51], s67 offen sc1
    v_mfma_f32_16x16x32_bf16 v[44:47], v[152:155], v[104:107], 0
    v_mfma_f32_16x16x32_bf16 v[48:51], v[156:159], v[104:107], 0
    v_mfma_f32_16x16x32_bf16 v[52:55], v[160:163], v[104:107], 0
    v_mfma_f32_16x16x32_bf16 v[56:59], v[164:167], v[104:107], 0
    v_mfma_f32_16x16x32_bf16 v[60:63], v[148:151], v[108:111], 0
    buffer_load_dwordx4 v[104:107], v9, s[48:51], s67 offen sc1
    v_mfma_f32_16x16x32_bf16 v[64:67], v[152:155], v[108:111], 0
    v_mfma_f32_16x16x32_bf16 v[68:71], v[156:159], v[108:111], 0
    v_mfma_f32_16x16x32_bf16 v[72:75], v[160:163], v[108:111], 0
    v_mfma_f32_16x16x32_bf16 v[76:79], v[164:167], v[108:111], 0
    v_mfma_f32_16x16x32_bf16 v[80:83], v[148:151], v[112:115], 0
    buffer_load_dwordx4 v[108:111], v10, s[48:51], s67 offen sc1
    v_mfma_f32_16x16x32_bf16 v[84:87], v[152:155], v[112:115], 0
    v_mfma_f32_16x16x32_bf16 v[88:91], v[156:159], v[112:115], 0
    v_mfma_f32_16x16x32_bf16 v[92:95], v[160:163], v[112:115], 0
    v_mfma_f32_16x16x32_bf16 v[96:99], v[164:167], v[112:115], 0
    buffer_load_dwordx4 v[112:115], v11, s[48:51], s67 offen sc1
    s_add_u32 s67, s67, 16384
    s_waitcnt vmcnt(8)
    v_mfma_f32_16x16x32_bf16 v[20:23], v[168:171], v[116:119], v[20:23]
    v_mfma_f32_16x16x32_bf16 v[24:27], v[172:175], v[116:119], v[24:27]
    v_mfma_f32_16x16x32_bf16 v[28:31], v[176:179], v[116:119], v[28:31]
    buffer_load_dwordx4 v[148:151], v3, s[48:51], s72 offen offset:0 sc1
    v_mfma_f32_16x16x32_bf16 v[32:35], v[180:183], v[116:119], v[32:35]
    v_mfma_f32_16x16x32_bf16 v[36:39], v[184:187], v[116:119], v[36:39]
    v_mfma_f32_16x16x32_bf16 v[40:43], v[168:171], v[120:123], v[40:43]
    buffer_load_dwordx4 v[116:119], v8, s[48:51], s67 offen sc1
    v_mfma_f32_16x16x32_bf16 v[44:47], v[172:175], v[120:123], v[44:47]
    v_mfma_f32_16x16x32_bf16 v[48:51], v[176:179], v[120:123], v[48:51]
    buffer_load_dwordx4 v[152:155], v3, s[48:51], s72 offen offset:1024 sc1
    v_mfma_f32_16x16x32_bf16 v[52:55], v[180:183], v[120:123], v[52:55]
    v_mfma_f32_16x16x32_bf16 v[56:59], v[184:187], v[120:123], v[56:59]
    v_mfma_f32_16x16x32_bf16 v[60:63], v[168:171], v[124:127], v[60:63]
    buffer_load_dwordx4 v[120:123], v9, s[48:51], s67 offen sc1
    v_mfma_f32_16x16x32_bf16 v[64:67], v[172:175], v[124:127], v[64:67]
    v_mfma_f32_16x16x32_bf16 v[68:71], v[176:179], v[124:127], v[68:71]
    buffer_load_dwordx4 v[156:159], v3, s[48:51], s72 offen offset:2048 sc1
    v_mfma_f32_16x16x32_bf16 v[72:75], v[180:183], v[124:127], v[72:75]
    v_mfma_f32_16x16x32_bf16 v[76:79], v[184:187], v[124:127], v[76:79]
    v_mfma_f32_16x16x32_bf16 v[80:83], v[168:171], v[128:131], v[80:83]
    buffer_load_dwordx4 v[124:127], v10, s[48:51], s67 offen sc1
    v_mfma_f32_16x16x32_bf16 v[84:87], v[172:175], v[128:131], v[84:87]
    v_mfma_f32_16x16x32_bf16 v[88:91], v[176:179], v[128:131], v[88:91]
    buffer_load_dwordx4 v[160:163], v3, s[48:51], s72 offen offset:3072 sc1
    v_mfma_f32_16x16x32_bf16 v[92:95], v[180:183], v[128:131], v[92:95]
    v_mfma_f32_16x16x32_bf16 v[96:99], v[184:187], v[128:131], v[96:99]
    buffer_load_dwordx4 v[128:131], v11, s[48:51], s67 offen sc1
    s_add_u32 s67, s67, 81920
    s_waitcnt vmcnt(12)
    v_mfma_f32_16x16x32_bf16 v[20:23], v[188:191], v[132:135], v[20:23]
    v_mfma_f32_16x16x32_bf16 v[24:27], v[192:195], v[132:135], v[24:27]
    v_mfma_f32_16x16x32_bf16 v[28:31], v[196:199], v[132:135], v[28:31]
    buffer_load_dwordx4 v[164:167], v4, s[48:51], s72 offen offset:0 sc1
    s_add_u32 s72, s72, 20480
    v_mfma_f32_16x16x32_bf16 v[32:35], v[200:203], v[132:135], v[32:35]
    v_mfma_f32_16x16x32_bf16 v[36:39], v[204:207], v[132:135], v[36:39]
    v_mfma_f32_16x16x32_bf16 v[40:43], v[188:191], v[136:139], v[40:43]
    buffer_load_dwordx4 v[132:135], v8, s[48:51], s67 offen sc1
    v_mfma_f32_16x16x32_bf16 v[44:47], v[192:195], v[136:139], v[44:47]
    v_mfma_f32_16x16x32_bf16 v[48:51], v[196:199], v[136:139], v[48:51]
    buffer_load_dwordx4 v[168:171], v3, s[48:51], s72 offen offset:0 sc1
    v_mfma_f32_16x16x32_bf16 v[52:55], v[200:203], v[136:139], v[52:55]
    v_mfma_f32_16x16x32_bf16 v[56:59], v[204:207], v[136:139], v[56:59]
    v_mfma_f32_16x16x32_bf16 v[60:63], v[188:191], v[140:143], v[60:63]
    buffer_load_dwordx4 v[136:139], v9, s[48:51], s67 offen sc1
    v_mfma_f32_16x16x32_bf16 v[64:67], v[192:195], v[140:143], v[64:67]
    v_mfma_f32_16x16x32_bf16 v[68:71], v[196:199], v[140:143], v[68:71]
    buffer_load_dwordx4 v[172:175], v3, s[48:51], s72 offen offset:1024 sc1
    v_mfma_f32_16x16x32_bf16 v[72:75], v[200:203], v[140:143], v[72:75]
    v_mfma_f32_16x16x32_bf16 v[76:79], v[204:207], v[140:143], v[76:79]
    v_mfma_f32_16x16x32_bf16 v[80:83], v[188:191], v[144:147], v[80:83]
    buffer_load_dwordx4 v[140:143], v10, s[48:51], s67 offen sc1
    v_mfma_f32_16x16x32_bf16 v[84:87], v[192:195], v[144:147], v[84:87]
    v_mfma_f32_16x16x32_bf16 v[88:91], v[196:199], v[144:147], v[88:91]
    v_mfma_f32_16x16x32_bf16 v[92:95], v[200:203], v[144:147], v[92:95]
    v_mfma_f32_16x16x32_bf16 v[96:99], v[204:207], v[144:147], v[96:99]
    buffer_load_dwordx4 v[144:147], v11, s[48:51], s67 offen sc1
    s_add_u32 s67, s67, 16384
    s_waitcnt vmcnt(15)
    v_mfma_f32_16x16x32_bf16 v[20:23], v[208:211], v[100:103], v[20:23]
    v_mfma_f32_16x16x32_bf16 v[24:27], v[212:215], v[100:103], v[24:27]
    v_mfma_f32_16x16x32_bf16 v[28:31], v[216:219], v[100:103], v[28:31]
    buffer_load_dwordx4 v[176:179], v3, s[48:51], s72 offen offset:2048 sc1
    v_mfma_f32_16x16x32_bf16 v[32:35], v[220:223], v[100:103], v[32:35]
    v_mfma_f32_16x16x32_bf16 v[36:39], v[224:227], v[100:103], v[36:39]
    v_mfma_f32_16x16x32_bf16 v[40:43], v[208:211], v[104:107], v[40:43]
    buffer_load_dwordx4 v[100:103], v8, s[48:51], s67 offen sc1
    v_mfma_f32_16x16x32_bf16 v[44:47], v[212:215], v[104:107], v[44:47]
    v_mfma_f32_16x16x32_bf16 v[48:51], v[216:219], v[104:107], v[48:51]
    buffer_load_dwordx4 v[180:183], v3, s[48:51], s72 offen offset:3072 sc1
    v_mfma_f32_16x16x32_bf16 v[52:55], v[220:223], v[104:107], v[52:55]
    v_mfma_f32_16x16x32_bf16 v[56:59], v[224:227], v[104:107], v[56:59]
    v_mfma_f32_16x16x32_bf16 v[60:63], v[208:211], v[108:111], v[60:63]
    buffer_load_dwordx4 v[104:107], v9, s[48:51], s67 offen sc1
    v_mfma_f32_16x16x32_bf16 v[64:67], v[212:215], v[108:111], v[64:67]
    v_mfma_f32_16x16x32_bf16 v[68:71], v[216:219], v[108:111], v[68:71]
    buffer_load_dwordx4 v[184:187], v4, s[48:51], s72 offen offset:0 sc1
    s_add_u32 s72, s72, 20480
    v_mfma_f32_16x16x32_bf16 v[72:75], v[220:223], v[108:111], v[72:75]
    v_mfma_f32_16x16x32_bf16 v[76:79], v[224:227], v[108:111], v[76:79]
    v_mfma_f32_16x16x32_bf16 v[80:83], v[208:211], v[112:115], v[80:83]
    buffer_load_dwordx4 v[108:111], v10, s[48:51], s67 offen sc1
    v_mfma_f32_16x16x32_bf16 v[84:87], v[212:215], v[112:115], v[84:87]
    v_mfma_f32_16x16x32_bf16 v[88:91], v[216:219], v[112:115], v[88:91]
    v_mfma_f32_16x16x32_bf16 v[92:95], v[220:223], v[112:115], v[92:95]
    v_mfma_f32_16x16x32_bf16 v[96:99], v[224:227], v[112:115], v[96:99]
    buffer_load_dwordx4 v[112:115], v11, s[48:51], s67 offen sc1
    s_add_u32 s67, s67, -81920
    s_waitcnt vmcnt(14)
    v_mfma_f32_16x16x32_bf16 v[20:23], v[228:231], v[116:119], v[20:23]
    v_mfma_f32_16x16x32_bf16 v[24:27], v[232:235], v[116:119], v[24:27]
    v_mfma_f32_16x16x32_bf16 v[28:31], v[236:239], v[116:119], v[28:31]
    buffer_load_dwordx4 v[208:211], v3, s[48:51], s72 offen offset:0 sc1
    v_mfma_f32_16x16x32_bf16 v[32:35], v[240:243], v[116:119], v[32:35]
    v_mfma_f32_16x16x32_bf16 v[36:39], v[244:247], v[116:119], v[36:39]
    v_mfma_f32_16x16x32_bf16 v[40:43], v[228:231], v[120:123], v[40:43]
    buffer_load_dwordx4 v[116:119], v8, s[48:51], s67 offen sc1
    v_mfma_f32_16x16x32_bf16 v[44:47], v[232:235], v[120:123], v[44:47]
    v_mfma_f32_16x16x32_bf16 v[48:51], v[236:239], v[120:123], v[48:51]
    buffer_load_dwordx4 v[212:215], v3, s[48:51], s72 offen offset:1024 sc1
    v_mfma_f32_16x16x32_bf16 v[52:55], v[240:243], v[120:123], v[52:55]
    v_mfma_f32_16x16x32_bf16 v[56:59], v[244:247], v[120:123], v[56:59]
    v_mfma_f32_16x16x32_bf16 v[60:63], v[228:231], v[124:127], v[60:63]
    buffer_load_dwordx4 v[120:123], v9, s[48:51], s67 offen sc1
    v_mfma_f32_16x16x32_bf16 v[64:67], v[232:235], v[124:127], v[64:67]
    v_mfma_f32_16x16x32_bf16 v[68:71], v[236:239], v[124:127], v[68:71]
    buffer_load_dwordx4 v[216:219], v3, s[48:51], s72 offen offset:2048 sc1
    v_mfma_f32_16x16x32_bf16 v[72:75], v[240:243], v[124:127], v[72:75]
    v_mfma_f32_16x16x32_bf16 v[76:79], v[244:247], v[124:127], v[76:79]
    v_mfma_f32_16x16x32_bf16 v[80:83], v[228:231], v[128:131], v[80:83]
    buffer_load_dwordx4 v[124:127], v10, s[48:51], s67 offen sc1
    v_mfma_f32_16x16x32_bf16 v[84:87], v[232:235], v[128:131], v[84:87]
    v_mfma_f32_16x16x32_bf16 v[88:91], v[236:239], v[128:131], v[88:91]
    v_mfma_f32_16x16x32_bf16 v[92:95], v[240:243], v[128:131], v[92:95]
    v_mfma_f32_16x16x32_bf16 v[96:99], v[244:247], v[128:131], v[96:99]
    buffer_load_dwordx4 v[128:131], v11, s[48:51], s67 offen sc1
    s_add_u32 s67, s67, 98304
    s_waitcnt vmcnt(14)
    v_mfma_f32_16x16x32_bf16 v[20:23], v[148:151], v[132:135], v[20:23]
    v_mfma_f32_16x16x32_bf16 v[24:27], v[152:155], v[132:135], v[24:27]
    v_mfma_f32_16x16x32_bf16 v[28:31], v[156:159], v[132:135], v[28:31]
    buffer_load_dwordx4 v[220:223], v3, s[48:51], s72 offen offset:3072 sc1
    v_mfma_f32_16x16x32_bf16 v[32:35], v[160:163], v[132:135], v[32:35]
    v_mfma_f32_16x16x32_bf16 v[36:39], v[164:167], v[132:135], v[36:39]
    v_mfma_f32_16x16x32_bf16 v[40:43], v[148:151], v[136:139], v[40:43]
    buffer_load_dwordx4 v[132:135], v8, s[48:51], s67 offen sc1
    v_mfma_f32_16x16x32_bf16 v[44:47], v[152:155], v[136:139], v[44:47]
    v_mfma_f32_16x16x32_bf16 v[48:51], v[156:159], v[136:139], v[48:51]
    buffer_load_dwordx4 v[224:227], v4, s[48:51], s72 offen offset:0 sc1
    s_add_u32 s72, s72, 20480
    v_mfma_f32_16x16x32_bf16 v[52:55], v[160:163], v[136:139], v[52:55]
    v_mfma_f32_16x16x32_bf16 v[56:59], v[164:167], v[136:139], v[56:59]
    v_mfma_f32_16x16x32_bf16 v[60:63], v[148:151], v[140:143], v[60:63]
    buffer_load_dwordx4 v[136:139], v9, s[48:51], s67 offen sc1
    v_mfma_f32_16x16x32_bf16 v[64:67], v[152:155], v[140:143], v[64:67]
    v_mfma_f32_16x16x32_bf16 v[68:71], v[156:159], v[140:143], v[68:71]
    v_mfma_f32_16x16x32_bf16 v[72:75], v[160:163], v[140:143], v[72:75]
    v_mfma_f32_16x16x32_bf16 v[76:79], v[164:167], v[140:143], v[76:79]
    v_mfma_f32_16x16x32_bf16 v[80:83], v[148:151], v[144:147], v[80:83]
    buffer_load_dwordx4 v[140:143], v10, s[48:51], s67 offen sc1
    v_mfma_f32_16x16x32_bf16 v[84:87], v[152:155], v[144:147], v[84:87]
    v_mfma_f32_16x16x32_bf16 v[88:91], v[156:159], v[144:147], v[88:91]
    v_mfma_f32_16x16x32_bf16 v[92:95], v[160:163], v[144:147], v[92:95]
    v_mfma_f32_16x16x32_bf16 v[96:99], v[164:167], v[144:147], v[96:99]
    buffer_load_dwordx4 v[144:147], v11, s[48:51], s67 offen sc1
    s_add_u32 s67, s67, -81920
    s_waitcnt vmcnt(13)
    s_lshl_b32 s76, s52, 2
    s_add_u32 s76, s76, 163632
    v_mov_b32 v18, s76
    s_mov_b32 s69, 0
L_lwW:
    ds_read_b32 v19, v18
    s_add_u32 s69, s69, 1
    s_waitcnt lgkmcnt(0)
    v_readfirstlane_b32 s76, v19
    s_nop 0
    s_cmp_ge_u32 s76, 1
    s_cbranch_scc1 L_lwdW
    s_cmp_lt_u32 s69, 0x100000
    s_cbranch_scc1 L_lwW
L_lwdW:
    v_mfma_f32_16x16x32_bf16 v[20:23], v[168:171], v[100:103], v[20:23]
    v_mfma_f32_16x16x32_bf16 v[24:27], v[172:175], v[100:103], v[24:27]
    ds_read_b128 v[188:191], v7 offset:0
    v_mfma_f32_16x16x32_bf16 v[28:31], v[176:179], v[100:103], v[28:31]
    buffer_load_dwordx4 v[148:151], v3, s[48:51], s72 offen offset:0 sc1
    v_mfma_f32_16x16x32_bf16 v[32:35], v[180:183], v[100:103], v[32:35]
    ds_read_b128 v[192:195], v7 offset:1024
    v_mfma_f32_16x16x32_bf16 v[36:39], v[184:187], v[100:103], v[36:39]
    v_mfma_f32_16x16x32_bf16 v[40:43], v[168:171], v[104:107], v[40:43]
    buffer_load_dwordx4 v[100:103], v8, s[48:51], s67 offen sc1
    v_mfma_f32_16x16x32_bf16 v[44:47], v[172:175], v[104:107], v[44:47]
    ds_read_b128 v[196:199], v7 offset:2048
    v_mfma_f32_16x16x32_bf16 v[48:51], v[176:179], v[104:107], v[48:51]
    buffer_load_dwordx4 v[152:155], v3, s[48:51], s72 offen offset:1024 sc1
    v_mfma_f32_16x16x32_bf16 v[52:55], v[180:183], v[104:107], v[52:55]
    ds_read_b128 v[200:203], v7 offset:3072
    v_mfma_f32_16x16x32_bf16 v[56:59], v[184:187], v[104:107], v[56:59]
    v_mfma_f32_16x16x32_bf16 v[60:63], v[168:171], v[108:111], v[60:63]
    buffer_load_dwordx4 v[104:107], v9, s[48:51], s67 offen sc1
    v_mfma_f32_16x16x32_bf16 v[64:67], v[172:175], v[108:111], v[64:67]
    ds_read_b128 v[204:207], v7 offset:4096
    v_mfma_f32_16x16x32_bf16 v[68:71], v[176:179], v[108:111], v[68:71]
    buffer_load_dwordx4 v[156:159], v3, s[48:51], s72 offen offset:2048 sc1
    v_mfma_f32_16x16x32_bf16 v[72:75], v[180:183], v[108:111], v[72:75]
    v_mfma_f32_16x16x32_bf16 v[76:79], v[184:187], v[108:111], v[76:79]
    v_mfma_f32_16x16x32_bf16 v[80:83], v[168:171], v[112:115], v[80:83]
    buffer_load_dwordx4 v[108:111], v10, s[48:51], s67 offen sc1
    v_mfma_f32_16x16x32_bf16 v[84:87], v[172:175], v[112:115], v[84:87]
    v_mfma_f32_16x16x32_bf16 v[88:91], v[176:179], v[112:115], v[88:91]
    v_mfma_f32_16x16x32_bf16 v[92:95], v[180:183], v[112:115], v[92:95]
    v_mfma_f32_16x16x32_bf16 v[96:99], v[184:187], v[112:115], v[96:99]
    buffer_load_dwordx4 v[112:115], v11, s[48:51], s67 offen sc1
    s_add_u32 s67, s67, 98304
    s_waitcnt vmcnt(13) lgkmcnt(0)
    v_mfma_f32_16x16x32_bf16 v[20:23], v[188:191], v[116:119], v[20:23]
    v_mfma_f32_16x16x32_bf16 v[24:27], v[192:195], v[116:119], v[24:27]
    v_mfma_f32_16x16x32_bf16 v[28:31], v[196:199], v[116:119], v[28:31]
    buffer_load_dwordx4 v[160:163], v3, s[48:51], s72 offen offset:3072 sc1
    v_mfma_f32_16x16x32_bf16 v[32:35], v[200:203], v[116:119], v[32:35]
    v_mfma_f32_16x16x32_bf16 v[36:39], v[204:207], v[116:119], v[36:39]
    v_mfma_f32_16x16x32_bf16 v[40:43], v[188:191], v[120:123], v[40:43]
    buffer_load_dwordx4 v[116:119], v8, s[48:51], s67 offen sc1
    v_mfma_f32_16x16x32_bf16 v[44:47], v[192:195], v[120:123], v[44:47]
    v_mfma_f32_16x16x32_bf16 v[48:51], v[196:199], v[120:123], v[48:51]
    buffer_load_dwordx4 v[164:167], v4, s[48:51], s72 offen offset:0 sc1
    s_add_u32 s72, s72, 20480
    v_mfma_f32_16x16x32_bf16 v[52:55], v[200:203], v[120:123], v[52:55]
    v_mfma_f32_16x16x32_bf16 v[56:59], v[204:207], v[120:123], v[56:59]
    v_mfma_f32_16x16x32_bf16 v[60:63], v[188:191], v[124:127], v[60:63]
    buffer_load_dwordx4 v[120:123], v9, s[48:51], s67 offen sc1
    v_mfma_f32_16x16x32_bf16 v[64:67], v[192:195], v[124:127], v[64:67]
    v_mfma_f32_16x16x32_bf16 v[68:71], v[196:199], v[124:127], v[68:71]
    v_mfma_f32_16x16x32_bf16 v[72:75], v[200:203], v[124:127], v[72:75]
    v_mfma_f32_16x16x32_bf16 v[76:79], v[204:207], v[124:127], v[76:79]
    v_mfma_f32_16x16x32_bf16 v[80:83], v[188:191], v[128:131], v[80:83]
    buffer_load_dwordx4 v[124:127], v10, s[48:51], s67 offen sc1
    v_mfma_f32_16x16x32_bf16 v[84:87], v[192:195], v[128:131], v[84:87]
    v_mfma_f32_16x16x32_bf16 v[88:91], v[196:199], v[128:131], v[88:91]
    v_mfma_f32_16x16x32_bf16 v[92:95], v[200:203], v[128:131], v[92:95]
    v_mfma_f32_16x16x32_bf16 v[96:99], v[204:207], v[128:131], v[96:99]
    buffer_load_dwordx4 v[128:131], v11, s[48:51], s67 offen sc1
    s_add_u32 s67, s67, -81920
    s_waitcnt vmcnt(13)
    v_mfma_f32_16x16x32_bf16 v[20:23], v[208:211], v[132:135], v[20:23]
    v_mfma_f32_16x16x32_bf16 v[24:27], v[212:215], v[132:135], v[24:27]
    ds_read_b128 v[228:231], v7 offset:5120
    v_mfma_f32_16x16x32_bf16 v[28:31], v[216:219], v[132:135], v[28:31]
    v_mfma_f32_16x16x32_bf16 v[32:35], v[220:223], v[132:135], v[32:35]
    ds_read_b128 v[232:235], v7 offset:6144
    v_mfma_f32_16x16x32_bf16 v[36:39], v[224:227], v[132:135], v[36:39]
    v_mfma_f32_16x16x32_bf16 v[40:43], v[208:211], v[136:139], v[40:43]
    buffer_load_dwordx4 v[132:135], v8, s[48:51], s67 offen sc1
    v_mfma_f32_16x16x32_bf16 v[44:47], v[212:215], v[136:139], v[44:47]
    ds_read_b128 v[236:239], v7 offset:7168
    v_mfma_f32_16x16x32_bf16 v[48:51], v[216:219], v[136:139], v[48:51]
    v_mfma_f32_16x16x32_bf16 v[52:55], v[220:223], v[136:139], v[52:55]
    ds_read_b128 v[240:243], v7 offset:8192
    v_mfma_f32_16x16x32_bf16 v[56:59], v[224:227], v[136:139], v[56:59]
    v_mfma_f32_16x16x32_bf16 v[60:63], v[208:211], v[140:143], v[60:63]
    buffer_load_dwordx4 v[136:139], v9, s[48:51], s67 offen sc1
    v_mfma_f32_16x16x32_bf16 v[64:67], v[212:215], v[140:143], v[64:67]
    ds_read_b128 v[244:247], v7 offset:9216
    v_mfma_f32_16x16x32_bf16 v[68:71], v[216:219], v[140:143], v[68:71]
    v_mfma_f32_16x16x32_bf16 v[72:75], v[220:223], v[140:143], v[72:75]
    v_mfma_f32_16x16x32_bf16 v[76:79], v[224:227], v[140:143], v[76:79]
    v_mfma_f32_16x16x32_bf16 v[80:83], v[208:211], v[144:147], v[80:83]
    buffer_load_dwordx4 v[140:143], v10, s[48:51], s67 offen sc1
    v_mfma_f32_16x16x32_bf16 v[84:87], v[212:215], v[144:147], v[84:87]
    v_mfma_f32_16x16x32_bf16 v[88:91], v[216:219], v[144:147], v[88:91]
    v_mfma_f32_16x16x32_bf16 v[92:95], v[220:223], v[144:147], v[92:95]
    v_mfma_f32_16x16x32_bf16 v[96:99], v[224:227], v[144:147], v[96:99]
    buffer_load_dwordx4 v[144:147], v11, s[48:51], s67 offen sc1
    s_add_u32 s67, s67, 16384
    s_waitcnt vmcnt(10) lgkmcnt(0)
    v_mfma_f32_16x16x32_bf16 v[20:23], v[228:231], v[100:103], v[20:23]
    v_mfma_f32_16x16x32_bf16 v[24:27], v[232:235], v[100:103], v[24:27]
    v_mfma_f32_16x16x32_bf16 v[28:31], v[236:239], v[100:103], v[28:31]
    s_cmp_ge_u32 s52, 2
    s_cselect_b32 s72, s72, 1073741824
    buffer_load_dwordx4 v[208:211], v3, s[48:51], s72 offen offset:0 sc1
    v_mfma_f32_16x16x32_bf16 v[32:35], v[240:243], v[100:103], v[32:35]
    v_mfma_f32_16x16x32_bf16 v[36:39], v[244:247], v[100:103], v[36:39]
    v_mfma_f32_16x16x32_bf16 v[40:43], v[228:231], v[104:107], v[40:43]
    buffer_load_dwordx4 v[100:103], v8, s[48:51], s67 offen sc1
    v_mfma_f32_16x16x32_bf16 v[44:47], v[232:235], v[104:107], v[44:47]
    v_mfma_f32_16x16x32_bf16 v[48:51], v[236:239], v[104:107], v[48:51]
    buffer_load_dwordx4 v[212:215], v3, s[48:51], s72 offen offset:1024 sc1
    v_mfma_f32_16x16x32_bf16 v[52:55], v[240:243], v[104:107], v[52:55]
    v_mfma_f32_16x16x32_bf16 v[56:59], v[244:247], v[104:107], v[56:59]
    v_mfma_f32_16x16x32_bf16 v[60:63], v[228:231], v[108:111], v[60:63]
    buffer_load_dwordx4 v[104:107], v9, s[48:51], s67 offen sc1
    v_mfma_f32_16x16x32_bf16 v[64:67], v[232:235], v[108:111], v[64:67]
    v_mfma_f32_16x16x32_bf16 v[68:71], v[236:239], v[108:111], v[68:71]
    buffer_load_dwordx4 v[216:219], v3, s[48:51], s72 offen offset:2048 sc1
    v_mfma_f32_16x16x32_bf16 v[72:75], v[240:243], v[108:111], v[72:75]
    v_mfma_f32_16x16x32_bf16 v[76:79], v[244:247], v[108:111], v[76:79]
    v_mfma_f32_16x16x32_bf16 v[80:83], v[228:231], v[112:115], v[80:83]
    buffer_load_dwordx4 v[108:111], v10, s[48:51], s67 offen sc1
    v_mfma_f32_16x16x32_bf16 v[84:87], v[232:235], v[112:115], v[84:87]
    v_mfma_f32_16x16x32_bf16 v[88:91], v[236:239], v[112:115], v[88:91]
    v_mfma_f32_16x16x32_bf16 v[92:95], v[240:243], v[112:115], v[92:95]
    v_mfma_f32_16x16x32_bf16 v[96:99], v[244:247], v[112:115], v[96:99]
    buffer_load_dwordx4 v[112:115], v11, s[48:51], s67 offen sc1
    s_add_u32 s67, s67, 81920
    s_waitcnt vmcnt(11)
    v_mfma_f32_16x16x32_bf16 v[20:23], v[148:151], v[116:119], v[20:23]
    v_mfma_f32_16x16x32_bf16 v[24:27], v[152:155], v[116:119], v[24:27]
    ds_read_b128 v[168:171], v7 offset:10240
    v_mfma_f32_16x16x32_bf16 v[28:31], v[156:159], v[116:119], v[28:31]
    buffer_load_dwordx4 v[220:223], v3, s[48:51], s72 offen offset:3072 sc1
    v_mfma_f32_16x16x32_bf16 v[32:35], v[160:163], v[116:119], v[32:35]
    ds_read_b128 v[172:175], v7 offset:11264
    v_mfma_f32_16x16x32_bf16 v[36:39], v[164:167], v[116:119], v[36:39]
    v_mfma_f32_16x16x32_bf16 v[40:43], v[148:151], v[120:123], v[40:43]
    s_cmp_ge_u32 s52, 2
    s_cselect_b32 s67, s67, 1073741824
    buffer_load_dwordx4 v[116:119], v8, s[48:51], s67 offen sc1
    v_mfma_f32_16x16x32_bf16 v[44:47], v[152:155], v[120:123], v[44:47]
    ds_read_b128 v[176:179], v7 offset:12288
    v_mfma_f32_16x16x32_bf16 v[48:51], v[156:159], v[120:123], v[48:51]
    buffer_load_dwordx4 v[224:227], v4, s[48:51], s72 offen offset:0 sc1
    v_mfma_f32_16x16x32_bf16 v[52:55], v[160:163], v[120:123], v[52:55]
    ds_read_b128 v[180:183], v7 offset:13312
    v_mfma_f32_16x16x32_bf16 v[56:59], v[164:167], v[120:123], v[56:59]
    v_mfma_f32_16x16x32_bf16 v[60:63], v[148:151], v[124:127], v[60:63]
    buffer_load_dwordx4 v[120:123], v9, s[48:51], s67 offen sc1
    v_mfma_f32_16x16x32_bf16 v[64:67], v[152:155], v[124:127], v[64:67]
    ds_read_b128 v[184:187], v7 offset:14336
    v_mfma_f32_16x16x32_bf16 v[68:71], v[156:159], v[124:127], v[68:71]
    v_mfma_f32_16x16x32_bf16 v[72:75], v[160:163], v[124:127], v[72:75]
    v_mfma_f32_16x16x32_bf16 v[76:79], v[164:167], v[124:127], v[76:79]
    v_mfma_f32_16x16x32_bf16 v[80:83], v[148:151], v[128:131], v[80:83]
    buffer_load_dwordx4 v[124:127], v10, s[48:51], s67 offen sc1
    v_mfma_f32_16x16x32_bf16 v[84:87], v[152:155], v[128:131], v[84:87]
    v_mfma_f32_16x16x32_bf16 v[88:91], v[156:159], v[128:131], v[88:91]
    v_mfma_f32_16x16x32_bf16 v[92:95], v[160:163], v[128:131], v[92:95]
    v_mfma_f32_16x16x32_bf16 v[96:99], v[164:167], v[128:131], v[96:99]
    buffer_load_dwordx4 v[128:131], v11, s[48:51], s67 offen sc1
    s_waitcnt vmcnt(13) lgkmcnt(0)
    v_mfma_f32_16x16x32_bf16 v[20:23], v[168:171], v[132:135], v[20:23]
    v_mfma_f32_16x16x32_bf16 v[24:27], v[172:175], v[132:135], v[24:27]
    ds_read_b128 v[188:191], v7 offset:15360
    v_mfma_f32_16x16x32_bf16 v[28:31], v[176:179], v[132:135], v[28:31]
    v_mfma_f32_16x16x32_bf16 v[32:35], v[180:183], v[132:135], v[32:35]
    ds_read_b128 v[192:195], v7 offset:16384
    v_mfma_f32_16x16x32_bf16 v[36:39], v[184:187], v[132:135], v[36:39]
    v_mfma_f32_16x16x32_bf16 v[40:43], v[168:171], v[136:139], v[40:43]
    v_mfma_f32_16x16x32_bf16 v[44:47], v[172:175], v[136:139], v[44:47]
    ds_read_b128 v[196:199], v7 offset:17408
    v_mfma_f32_16x16x32_bf16 v[48:51], v[176:179], v[136:139], v[48:51]
    v_mfma_f32_16x16x32_bf16 v[52:55], v[180:183], v[136:139], v[52:55]
    ds_read_b128 v[200:203], v7 offset:18432
    v_mfma_f32_16x16x32_bf16 v[56:59], v[184:187], v[136:139], v[56:59]
    v_mfma_f32_16x16x32_bf16 v[60:63], v[168:171], v[140:143], v[60:63]
    v_mfma_f32_16x16x32_bf16 v[64:67], v[172:175], v[140:143], v[64:67]
    ds_read_b128 v[204:207], v7 offset:19456
    v_mfma_f32_16x16x32_bf16 v[68:71], v[176:179], v[140:143], v[68:71]
    v_mfma_f32_16x16x32_bf16 v[72:75], v[180:183], v[140:143], v[72:75]
    v_mfma_f32_16x16x32_bf16 v[76:79], v[184:187], v[140:143], v[76:79]
    v_mfma_f32_16x16x32_bf16 v[80:83], v[168:171], v[144:147], v[80:83]
    v_mfma_f32_16x16x32_bf16 v[84:87], v[172:175], v[144:147], v[84:87]
    v_mfma_f32_16x16x32_bf16 v[88:91], v[176:179], v[144:147], v[88:91]
    v_mfma_f32_16x16x32_bf16 v[92:95], v[180:183], v[144:147], v[92:95]
    v_mfma_f32_16x16x32_bf16 v[96:99], v[184:187], v[144:147], v[96:99]
    s_waitcnt vmcnt(6) lgkmcnt(0)
    v_mov_b32 v18, 163596
    v_mov_b32 v19, 1
    s_mov_b64 exec, 1
    ds_add_u32 v18, v19
    s_mov_b64 exec, -1
    v_mfma_f32_16x16x32_bf16 v[20:23], v[188:191], v[100:103], v[20:23]
    v_mfma_f32_16x16x32_bf16 v[24:27], v[192:195], v[100:103], v[24:27]
    v_mfma_f32_16x16x32_bf16 v[28:31], v[196:199], v[100:103], v[28:31]
    v_mfma_f32_16x16x32_bf16 v[32:35], v[200:203], v[100:103], v[32:35]
    v_mfma_f32_16x16x32_bf16 v[36:39], v[204:207], v[100:103], v[36:39]
    v_mfma_f32_16x16x32_bf16 v[40:43], v[188:191], v[104:107], v[40:43]
    v_mfma_f32_16x16x32_bf16 v[44:47], v[192:195], v[104:107], v[44:47]
    v_mfma_f32_16x16x32_bf16 v[48:51], v[196:199], v[104:107], v[48:51]
    v_mfma_f32_16x16x32_bf16 v[52:55], v[200:203], v[104:107], v[52:55]
    v_mfma_f32_16x16x32_bf16 v[56:59], v[204:207], v[104:107], v[56:59]
    v_mfma_f32_16x16x32_bf16 v[60:63], v[188:191], v[108:111], v[60:63]
    v_mfma_f32_16x16x32_bf16 v[64:67], v[192:195], v[108:111], v[64:67]
    v_mfma_f32_16x16x32_bf16 v[68:71], v[196:199], v[108:111], v[68:71]
    v_mfma_f32_16x16x32_bf16 v[72:75], v[200:203], v[108:111], v[72:75]
    v_mfma_f32_16x16x32_bf16 v[76:79], v[204:207], v[108:111], v[76:79]
    v_mfma_f32_16x16x32_bf16 v[80:83], v[188:191], v[112:115], v[80:83]
    v_mfma_f32_16x16x32_bf16 v[84:87], v[192:195], v[112:115], v[84:87]
    v_mfma_f32_16x16x32_bf16 v[88:91], v[196:199], v[112:115], v[88:91]
    v_mfma_f32_16x16x32_bf16 v[92:95], v[200:203], v[112:115], v[92:95]
    v_mfma_f32_16x16x32_bf16 v[96:99], v[204:207], v[112:115], v[96:99]
    s_waitcnt vmcnt(0)
    s_xor_b32 s62, s52, 1
    s_mul_i32 s62, s62, 15360
    s_add_u32 s62, s62, 0
    v_add_u32 v9, s62, v3
    s_xor_b32 s62, s52, 2
    s_mul_i32 s62, s62, 15360
    s_add_u32 s62, s62, 5120
    v_add_u32 v10, s62, v3
    s_xor_b32 s62, s52, 3
    s_mul_i32 s62, s62, 15360
    s_add_u32 s62, s62, 10240
    v_add_u32 v11, s62, v3
    v_mov_b32 v18, 163596
    s_mov_b32 s69, 0
L_lwG:
    ds_read_b32 v19, v18
    s_add_u32 s69, s69, 1
    s_waitcnt lgkmcnt(0)
    v_readfirstlane_b32 s76, v19
    s_nop 0
    s_cmp_ge_u32 s76, 4
    s_cbranch_scc1 L_lwdG
    s_cmp_lt_u32 s69, 0x100000
    s_cbranch_scc1 L_lwG
L_lwdG:
    v_mfma_f32_16x16x32_bf16 v[40:43], v[208:211], v[120:123], v[40:43]
    v_mfma_f32_16x16x32_bf16 v[44:47], v[212:215], v[120:123], v[44:47]
    v_mfma_f32_16x16x32_bf16 v[48:51], v[216:219], v[120:123], v[48:51]
    v_mfma_f32_16x16x32_bf16 v[52:55], v[220:223], v[120:123], v[52:55]
    v_mfma_f32_16x16x32_bf16 v[56:59], v[224:227], v[120:123], v[56:59]
    v_mfma_f32_16x16x32_bf16 v[60:63], v[208:211], v[124:127], v[60:63]
    v_mfma_f32_16x16x32_bf16 v[64:67], v[212:215], v[124:127], v[64:67]
    s_nop 1
    ds_write_b128 v9, v[40:43] offset:0
    v_mfma_f32_16x16x32_bf16 v[68:71], v[216:219], v[124:127], v[68:71]
    ds_write_b128 v9, v[44:47] offset:1024
    v_mfma_f32_16x16x32_bf16 v[72:75], v[220:223], v[124:127], v[72:75]
    ds_write_b128 v9, v[48:51] offset:2048
    v_mfma_f32_16x16x32_bf16 v[76:79], v[224:227], v[124:127], v[76:79]
    ds_write_b128 v9, v[52:55] offset:3072
    v_mfma_f32_16x16x32_bf16 v[80:83], v[208:211], v[128:131], v[80:83]
    ds_write_b128 v9, v[56:59] offset:4096
    v_mfma_f32_16x16x32_bf16 v[84:87], v[212:215], v[128:131], v[84:87]
    ds_write_b128 v10, v[60:63] offset:0
    v_mfma_f32_16x16x32_bf16 v[88:91], v[216:219], v[128:131], v[88:91]
    ds_write_b128 v10, v[64:67] offset:1024
    v_mfma_f32_16x16x32_bf16 v[92:95], v[220:223], v[128:131], v[92:95]
    ds_write_b128 v10, v[68:71] offset:2048
    v_mfma_f32_16x16x32_bf16 v[96:99], v[224:227], v[128:131], v[96:99]
    ds_write_b128 v10, v[72:75] offset:3072
    v_mfma_f32_16x16x32_bf16 v[20:23], v[208:211], v[116:119], v[20:23]
    ds_write_b128 v10, v[76:79] offset:4096
    v_mfma_f32_16x16x32_bf16 v[24:27], v[212:215], v[116:119], v[24:27]
    ds_write_b128 v11, v[80:83] offset:0
    v_mfma_f32_16x16x32_bf16 v[28:31], v[216:219], v[116:119], v[28:31]
    ds_write_b128 v11, v[84:87] offset:1024
    v_mfma_f32_16x16x32_bf16 v[32:35], v[220:223], v[116:119], v[32:35]
    ds_write_b128 v11, v[88:91] offset:2048
    v_mfma_f32_16x16x32_bf16 v[36:39], v[224:227], v[116:119], v[36:39]
    ds_write_b128 v11, v[92:95] offset:3072
    ds_write_b128 v11, v[96:99] offset:4096
    s_mul_i32 s63, s52, 15360
    v_add_u32 v15, s63, v3
    s_mul_i32 s62, s52, 5120
    s_add_u32 s62, s62, 98304
    v_add_u32 v16, s62, v3
    s_waitcnt lgkmcnt(0)
    s_barrier
    ds_read_b128 v[100:103], v16 offset:0
    ds_read_b128 v[104:107], v16 offset:1024
    ds_read_b128 v[108:111], v16 offset:2048
    ds_read_b128 v[112:115], v16 offset:3072
    ds_read_b128 v[116:119], v16 offset:4096
    ds_read_b128 v[40:43], v15 offset:0
    ds_read_b128 v[44:47], v15 offset:1024
    ds_read_b128 v[48:51], v15 offset:2048
    ds_read_b128 v[52:55], v15 offset:3072
    ds_read_b128 v[56:59], v15 offset:4096
    ds_read_b128 v[60:63], v15 offset:5120
    ds_read_b128 v[64:67], v15 offset:6144
    ds_read_b128 v[68:71], v15 offset:7168
    ds_read_b128 v[72:75], v15 offset:8192
    ds_read_b128 v[76:79], v15 offset:9216
    s_waitcnt lgkmcnt(10)
    ds_read_b128 v[80:83], v15 offset:10240
    ds_read_b128 v[84:87], v15 offset:11264
    ds_read_b128 v[88:91], v15 offset:12288
    ds_read_b128 v[92:95], v15 offset:13312
    ds_read_b128 v[96:99], v15 offset:14336
    v_pk_add_f32 v[20:21], v[20:21], v[100:101]
    v_pk_add_f32 v[22:23], v[22:23], v[102:103]
    v_pk_add_f32 v[24:25], v[24:25], v[104:105]
    v_pk_add_f32 v[26:27], v[26:27], v[106:107]
    v_pk_add_f32 v[28:29], v[28:29], v[108:109]
    v_pk_add_f32 v[30:31], v[30:31], v[110:111]
    v_pk_add_f32 v[32:33], v[32:33], v[112:113]
    v_pk_add_f32 v[34:35], v[34:35], v[114:115]
    v_pk_add_f32 v[36:37], v[36:37], v[116:117]
    v_pk_add_f32 v[38:39], v[38:39], v[118:119]
    s_waitcnt lgkmcnt(10)
    v_pk_add_f32 v[20:21], v[20:21], v[40:41]
    v_pk_add_f32 v[22:23], v[22:23], v[42:43]
    v_pk_add_f32 v[24:25], v[24:25], v[44:45]
    v_pk_add_f32 v[26:27], v[26:27], v[46:47]
    v_pk_add_f32 v[28:29], v[28:29], v[48:49]
    v_pk_add_f32 v[30:31], v[30:31], v[50:51]
    v_pk_add_f32 v[32:33], v[32:33], v[52:53]
    v_pk_add_f32 v[34:35], v[34:35], v[54:55]
    v_pk_add_f32 v[36:37], v[36:37], v[56:57]
    v_pk_add_f32 v[38:39], v[38:39], v[58:59]
    s_waitcnt lgkmcnt(5)
    v_pk_add_f32 v[20:21], v[20:21], v[60:61]
    v_pk_add_f32 v[22:23], v[22:23], v[62:63]
    v_pk_add_f32 v[24:25], v[24:25], v[64:65]
    v_pk_add_f32 v[26:27], v[26:27], v[66:67]
    v_pk_add_f32 v[28:29], v[28:29], v[68:69]
    v_pk_add_f32 v[30:31], v[30:31], v[70:71]
    v_pk_add_f32 v[32:33], v[32:33], v[72:73]
    v_pk_add_f32 v[34:35], v[34:35], v[74:75]
    v_pk_add_f32 v[36:37], v[36:37], v[76:77]
    v_pk_add_f32 v[38:39], v[38:39], v[78:79]
    s_waitcnt lgkmcnt(0)
    v_pk_add_f32 v[20:21], v[20:21], v[80:81]
    v_pk_add_f32 v[22:23], v[22:23], v[82:83]
    v_pk_add_f32 v[24:25], v[24:25], v[84:85]
    v_pk_add_f32 v[26:27], v[26:27], v[86:87]
    v_pk_add_f32 v[28:29], v[28:29], v[88:89]
    v_pk_add_f32 v[30:31], v[30:31], v[90:91]
    v_pk_add_f32 v[32:33], v[32:33], v[92:93]
    v_pk_add_f32 v[34:35], v[34:35], v[94:95]
    v_pk_add_f32 v[36:37], v[36:37], v[96:97]
    v_pk_add_f32 v[38:39], v[38:39], v[98:99]
    v_mul_u32_u24 v16, 160, v1
    v_add_u32 v16, s63, v16
    v_lshl_add_u32 v17, v2, 4, v16
    v_lshl_add_u32 v16, v2, 3, v16
    v_cvt_pk_bf16_f32 v124, v20, v21
    v_cvt_pk_bf16_f32 v125, v22, v23
    v_cvt_pk_bf16_f32 v126, v24, v25
    v_cvt_pk_bf16_f32 v127, v26, v27
    ds_write_b128 v17, v[124:127]
    v_cvt_pk_bf16_f32 v128, v28, v29
    v_cvt_pk_bf16_f32 v129, v30, v31
    v_cvt_pk_bf16_f32 v130, v32, v33
    v_cvt_pk_bf16_f32 v131, v34, v35
    ds_write_b128 v17, v[128:131] offset:64
    v_cvt_pk_bf16_f32 v132, v36, v37
    v_cvt_pk_bf16_f32 v133, v38, v39
    ds_write_b64 v16, v[132:133] offset:128
    s_waitcnt lgkmcnt(0)
    ds_read_b128 v[124:127], v15
    ds_read_b128 v[128:131], v15 offset:1024
    ds_read_b128 v[132:135], v15 offset:2048
    s_waitcnt lgkmcnt(2)
    buffer_store_dwordx4 v[124:127], v5, s[44:47], s56 offen sc0 sc1
    s_waitcnt lgkmcnt(1)
    buffer_store_dwordx4 v[128:131], v6, s[44:47], s56 offen sc0 sc1
    s_waitcnt lgkmcnt(0)
    s_mov_b32 exec_hi, 0
    buffer_store_dwordx4 v[132:135], v12, s[44:47], s56 offen sc0 sc1
    s_mov_b32 exec_hi, -1
    s_branch L_fin
L_role_L:
    s_sub_u32 s52, s52, 4
    s_cmp_ge_u32 s52, 2
    s_cbranch_scc1 L_aux
    s_cmp_eq_u32 s57, 1
    s_cbranch_scc1 L_loader
    s_waitcnt lgkmcnt(0)
    s_mul_i32 s68, s68, 1664525
    s_add_u32 s68, s68, 1013904223
    s_barrier
    v_mov_b32 v18, 163608
    s_mov_b32 s69, 0
L_lwPI:
    ds_read_b32 v19, v18
    s_add_u32 s69, s69, 1
    s_waitcnt lgkmcnt(0)
    v_readfirstlane_b32 s76, v19
    s_nop 0
    s_cmp_ge_u32 s76, 2
    s_cbranch_scc1 L_lwdPI
    s_sleep 1
    s_cmp_lt_u32 s69, 0x100000
    s_cbranch_scc1 L_lwPI
L_lwdPI:
    s_mul_i32 s62, s53, 327680
    s_sub_u32 s63, s54, 28
    s_lshl_b32 s63, s63, 1
    s_add_u32 s63, s63, s52
    s_mul_i32 s63, s63, 40960
    s_add_u32 s62, s62, s63
    v_lshlrev_b32 v21, 7, v0
    buffer_load_dword v22, v21, s[20:23], s62 offen
    s_add_u32 s62, s62, 8192
    s_waitcnt vmcnt(1)
    buffer_load_dword v22, v21, s[20:23], s62 offen
    s_add_u32 s62, s62, 8192
    s_waitcnt vmcnt(1)
    buffer_load_dword v22, v21, s[20:23], s62 offen
    s_add_u32 s62, s62, 8192
    s_waitcnt vmcnt(1)
    buffer_load_dword v22, v21, s[20:23], s62 offen
    s_add_u32 s62, s62, 8192
    s_waitcnt vmcnt(1)
    buffer_load_dword v22, v21, s[20:23], s62 offen
    s_add_u32 s62, s62, 8192
    s_waitcnt vmcnt(1)
    s_branch L_aux_over
L_loader:
    s_lshl_b32 s62, s55, 7
    s_lshl_b32 s63, s52, 6
    s_add_u32 s62, s62, s63
    v_xor_b32 v22, v22, v21
    v_add_u32 v21, s62, v21
    v_mul_u32_u24 v21, 1280, v21
    v_lshl_add_u32 v24, v22, 4, v21
    s_lshl_b32 s62, s56, 8
    s_mul_i32 s63, s52, 110592
    s_add_u32 s62, s62, s63
    s_cmp_eq_u32 s56, 13
    s_cselect_b32 s63, 8, 16
    v_lshlrev_b32 v21, 1, v2
    v_xor_b32 v21, v21, v1
    v_mul_u32_u24 v22, 3456, v2
    v_add_u32 v22, s62, v22
    v_lshl_add_u32 v32, v21, 4, v22
    v_cmp_gt_u32 vcc, s63, v21
    v_xor_b32 v21, 8, v21
    v_add_u32 v22, 27648, v22
    v_cndmask_b32 v32, v20, v32, vcc
    v_lshl_add_u32 v34, v21, 4, v22
    v_cmp_gt_u32 vcc, s63, v21
    s_mov_b32 s75, 0
    v_lshlrev_b32 v12, 7, v1
    s_lshl_b32 s74, s52, 13
    v_cndmask_b32 v34, v20, v34, vcc
    v_add_u32 v25, 10240, v24
    v_add_u32 v33, 13824, v32
    v_add_u32 v26, 20480, v24
    v_add_u32 v27, 30720, v24
    v_add_u32 v35, 13824, v34
    v_add_u32 v28, 40960, v24
    v_add_u32 v36, 55296, v32
    v_add_u32 v29, 51200, v24
    v_add_u32 v37, 69120, v32
    v_add_u32 v30, 61440, v24
    v_add_u32 v38, 55296, v34
    v_add_u32 v31, 71680, v24
    v_add_u32 v39, 69120, v34
    s_mul_i32 s63, s55, 3
    s_mul_i32 s75, s56, 1
    s_add_u32 s75, s75, s63
    s_lshr_b32 s75, s75, 1
    s_mul_i32 s63, s75, 6554
    s_lshr_b32 s63, s63, 16
    s_mul_i32 s63, s63, 10
    s_sub_u32 s75, s75, s63
    s_mov_b32 s61, 0
L_ld:
    s_lshl_b32 s62, s75, 7
    s_mul_i32 s63, s75, 221184
    s_add_u32 m0, s74, 0
    s_nop 0
    buffer_load_dwordx4 v24, s[4:7], s62 offen lds
    s_add_u32 m0, s74, 16384
    s_nop 0
    buffer_load_dwordx4 v32, s[28:31], s63 offen lds
    s_add_u32 m0, s74, 1024
    s_nop 0
    buffer_load_dwordx4 v25, s[4:7], s62 offen lds
    s_add_u32 m0, s74, 17408
    s_nop 0
    buffer_load_dwordx4 v33, s[28:31], s63 offen lds
    s_add_u32 m0, s74, 2048
    s_nop 0
    buffer_load_dwordx4 v26, s[4:7], s62 offen lds
    s_add_u32 m0, s74, 18432
    s_nop 0
    buffer_load_dwordx4 v34, s[28:31], s63 offen lds
    s_add_u32 m0, s74, 3072
    s_nop 0
    buffer_load_dwordx4 v27, s[4:7], s62 offen lds
    s_add_u32 m0, s74, 19456
    s_nop 0
    buffer_load_dwordx4 v35, s[28:31], s63 offen lds
    s_add_u32 m0, s74, 4096
    s_nop 0
    buffer_load_dwordx4 v28, s[4:7], s62 offen lds
    s_add_u32 m0, s74, 20480
    s_nop 0
    buffer_load_dwordx4 v36, s[28:31], s63 offen lds
    s_add_u32 m0, s74, 5120
    s_nop 0
    buffer_load_dwordx4 v29, s[4:7], s62 offen lds
    s_add_u32 m0, s74, 21504
    s_nop 0
    buffer_load_dwordx4 v37, s[28:31], s63 offen lds
    s_add_u32 m0, s74, 6144
    s_nop 0
    buffer_load_dwordx4 v30, s[4:7], s62 offen lds
    s_add_u32 m0, s74, 22528
    s_nop 0
    buffer_load_dwordx4 v38, s[28:31], s63 offen lds
    s_add_u32 m0, s74, 7168
    s_nop 0
    buffer_load_dwordx4 v31, s[4:7], s62 offen lds
    s_add_u32 m0, s74, 23552
    s_nop 0
    buffer_load_dwordx4 v39, s[28:31], s63 offen lds
    s_add_u32 s75, s75, 1
    s_cmp_eq_u32 s75, 10
    s_cselect_b32 s75, 0, s75
    s_add_u32 s74, s74, 32768
    s_cmp_ge_u32 s74, 98304
    s_cselect_b32 s62, 98304, 0
    s_sub_u32 s74, s74, s62
    s_add_u32 s61, s61, 1
    s_cmp_eq_u32 s61, 1
    s_cbranch_scc1 L_ld
    s_cmp_eq_u32 s61, 7
    s_cbranch_scc1 L_ld_a
    s_cmp_eq_u32 s61, 8
    s_cbranch_scc1 L_ld_b
    s_cmp_eq_u32 s61, 9
    s_cbranch_scc1 L_ld_c
    s_waitcnt vmcnt(16)
L_ld_bar:
    s_barrier
    s_cmp_lt_u32 s61, 10
    s_cbranch_scc1 L_ld
    s_waitcnt vmcnt(0)
    s_barrier
    s_branch L_aux_over
L_ld_a:
    s_lshl_b32 s70, s55, 1
    s_add_u32 s70, s70, s52
    s_lshl_b32 s67, s70, 11
    s_add_u32 s67, s67, 17629184
    buffer_load_dword v16, v12, s[48:51], s67 offen sc1
    s_waitcnt vmcnt(17)
    s_branch L_ld_bar
L_ld_b:
    s_waitcnt lgkmcnt(0)
    s_mul_i32 s68, s68, 1664525
    s_add_u32 s68, s68, 1013904223
    s_waitcnt vmcnt(16)
    v_cmp_eq_u32 vcc, s68, v16
    s_nop 0
    s_cmp_eq_u64 vcc, -1
    s_cbranch_scc1 L_polldS
    s_mov_b32 s69, 0
L_pollS:
    buffer_load_dword v16, v12, s[48:51], s67 offen sc1
    s_waitcnt vmcnt(0)
    v_cmp_eq_u32 vcc, s68, v16
    s_nop 0
    s_cmp_eq_u64 vcc, -1
    s_cbranch_scc1 L_polldS
    s_sleep 4
    s_add_u32 s69, s69, 1
    s_cmp_lt_u32 s69, 0x8000
    s_cbranch_scc1 L_pollS
L_polldS:
    s_lshl_b32 s70, s70, 9
    s_add_u32 s70, s70, 16777216
    v_lshlrev_b32 v21, 3, v0
    buffer_load_dwordx2 v[22:23], v21, s[48:51], s70 offen sc1
    s_lshl_b32 s62, s52, 9
    s_add_u32 s62, s62, 162560
    v_add_u32 v21, s62, v21
    s_waitcnt vmcnt(17)
    s_branch L_ld_bar
L_ld_c:
    s_waitcnt vmcnt(16)
    ds_write_b64 v21, v[22:23]
    s_waitcnt lgkmcnt(0)
    s_branch L_ld_bar
L_aux:
    s_and_b32 s75, s52, 1
    s_lshl_b32 s62, s53, 5
    s_add_u32 s62, s62, s54
    s_lshl_b32 s62, s62, 1
    s_add_u32 s66, s62, s75
    s_mul_i32 s62, s66, 5120
    v_mul_u32_u24 v14, 1280, v2
    v_lshl_add_u32 v14, v1, 4, v14
    buffer_load_dwordx4 v[24:27], v14, s[4:7], s62 offen offset:0
    buffer_load_dwordx4 v[28:31], v14, s[4:7], s62 offen offset:256
    buffer_load_dwordx4 v[32:35], v14, s[4:7], s62 offen offset:512
    buffer_load_dwordx4 v[36:39], v14, s[4:7], s62 offen offset:768
    buffer_load_dwordx4 v[40:43], v14, s[4:7], s62 offen offset:1024
    v_mov_b32 v23, 163584
    v_lshl_add_u32 v23, v16, 2, v23
    v_mov_b32 v48, 0
    ds_write_b32 v23, v48
    s_lshl_b32 s62, s75, 5
    v_add_u32 v21, s62, v21
    v_lshrrev_b32 v23, 1, v21
    v_xor_b32 v23, v23, v22
    v_and_b32 v23, 7, v23
    v_lshlrev_b32 v23, 4, v23
    v_lshl_add_u32 v12, v21, 7, v23
    v_xor_b32 v13, 64, v12
    v_lshlrev_b32 v4, 12, v21
    v_lshl_add_u32 v4, v22, 4, v4
    v_add_u32 v5, 32768, v4
    v_add_u32 v6, 65536, v4
    v_add_u32 v7, 98304, v4
    v_add_u32 v21, 0, v0
    v_mul_u32_u24 v22, 6554, v21
    v_lshrrev_b32 v22, 16, v22
    v_mul_u32_u24 v23, 10, v22
    v_sub_u32 v23, v21, v23
    v_mul_u32_u24 v22, 1280, v22
    v_lshl_add_u32 v104, v23, 4, v22
    v_add_u32 v21, 64, v0
    v_mul_u32_u24 v22, 6554, v21
    v_lshrrev_b32 v22, 16, v22
    v_mul_u32_u24 v23, 10, v22
    v_sub_u32 v23, v21, v23
    v_mul_u32_u24 v22, 1280, v22
    v_lshl_add_u32 v105, v23, 4, v22
    v_add_u32 v21, 128, v0
    v_mul_u32_u24 v22, 6554, v21
    v_lshrrev_b32 v22, 16, v22
    v_mul_u32_u24 v23, 10, v22
    v_sub_u32 v23, v21, v23
    v_mul_u32_u24 v22, 1280, v22
    v_lshl_add_u32 v106, v23, 4, v22
    v_add_u32 v21, 192, v0
    v_mul_u32_u24 v22, 6554, v21
    v_lshrrev_b32 v22, 16, v22
    v_mul_u32_u24 v23, 10, v22
    v_sub_u32 v23, v21, v23
    v_mul_u32_u24 v22, 1280, v22
    v_lshl_add_u32 v107, v23, 4, v22
    v_add_u32 v21, 256, v0
    v_mul_u32_u24 v22, 6554, v21
    v_lshrrev_b32 v22, 16, v22
    v_mul_u32_u24 v23, 10, v22
    v_sub_u32 v23, v21, v23
    v_mul_u32_u24 v22, 1280, v22
    v_lshl_add_u32 v108, v23, 4, v22
    s_lshl_b32 s72, s75, 5
    s_add_u32 s72, s72, s54
    s_cmp_eq_u32 s57, 1
    s_mov_b32 s62, 57344
    s_cselect_b32 s62, 126976, s62
    s_mul_i32 s67, s75, 5120
    s_add_u32 s67, s67, s62
    v_lshrrev_b32 v21, 2, v0
    v_mul_u32_u24 v21, 160, v21
    v_add_u32 v21, s67, v21
    v_and_b32 v22, 3, v0
    v_lshl_add_u32 v15, v22, 3, v21
    v_lshl_add_u32 v14, v22, 4, v21
    v_add_u32 v11, 4096, v3
    v_mov_b32 v92, -1
    v_mov_b32 v93, -1
    v_mov_b32 v94, -1
    v_mov_b32 v95, -1
    v_mov_b32 v21, 0x3f803f80
    s_waitcnt vmcnt(0)
    v_dot2_f32_bf16 v44, v24, v21, 0
    v_dot2_f32_bf16 v46, v24, v24, 0
    v_dot2_f32_bf16 v45, v25, v21, 0
    v_dot2_f32_bf16 v47, v25, v25, 0
    v_dot2_f32_bf16 v44, v26, v21, v44
    v_dot2_f32_bf16 v46, v26, v26, v46
    v_dot2_f32_bf16 v45, v27, v21, v45
    v_dot2_f32_bf16 v47, v27, v27, v47
    v_dot2_f32_bf16 v44, v28, v21, v44
    v_dot2_f32_bf16 v46, v28, v28, v46
    v_dot2_f32_bf16 v45, v29, v21, v45
    v_dot2_f32_bf16 v47, v29, v29, v47
    v_dot2_f32_bf16 v44, v30, v21, v44
    v_dot2_f32_bf16 v46, v30, v30, v46
    v_dot2_f32_bf16 v45, v31, v21, v45
    v_dot2_f32_bf16 v47, v31, v31, v47
    v_dot2_f32_bf16 v44, v32, v21, v44
    v_dot2_f32_bf16 v46, v32, v32, v46
    v_dot2_f32_bf16 v45, v33, v21, v45
    v_dot2_f32_bf16 v47, v33, v33, v47
    v_dot2_f32_bf16 v44, v34, v21, v44
    v_dot2_f32_bf16 v46, v34, v34, v46
    v_dot2_f32_bf16 v45, v35, v21, v45
    v_dot2_f32_bf16 v47, v35, v35, v47
    v_dot2_f32_bf16 v44, v36, v21, v44
    v_dot2_f32_bf16 v46, v36, v36, v46
    v_dot2_f32_bf16 v45, v37, v21, v45
    v_dot2_f32_bf16 v47, v37, v37, v47
    v_dot2_f32_bf16 v44, v38, v21, v44
    v_dot2_f32_bf16 v46, v38, v38, v46
    v_dot2_f32_bf16 v45, v39, v21, v45
    v_dot2_f32_bf16 v47, v39, v39, v47
    v_dot2_f32_bf16 v44, v40, v21, v44
    v_dot2_f32_bf16 v46, v40, v40, v46
    v_dot2_f32_bf16 v45, v41, v21, v45
    v_dot2_f32_bf16 v47, v41, v41, v47
    v_dot2_f32_bf16 v44, v42, v21, v44
    v_dot2_f32_bf16 v46, v42, v42, v46
    v_dot2_f32_bf16 v45, v43, v21, v45
    v_dot2_f32_bf16 v47, v43, v43, v47
    s_mov_b32 s62, 0x3acccccd
    s_mov_b32 s63, 0x3727c5ac
    s_nop 1
    v_add_f32 v44, v44, v45
    v_add_f32 v45, v46, v47
    s_nop 0
    v_add_f32_dpp v44, v44, v44 row_shr:1 row_mask:0xf bank_mask:0xf bound_ctrl:1
    v_add_f32_dpp v45, v45, v45 row_shr:1 row_mask:0xf bank_mask:0xf bound_ctrl:1
    s_nop 0
    v_add_f32_dpp v44, v44, v44 row_shr:2 row_mask:0xf bank_mask:0xf bound_ctrl:1
    v_add_f32_dpp v45, v45, v45 row_shr:2 row_mask:0xf bank_mask:0xf bound_ctrl:1
    s_nop 0
    v_add_f32_dpp v44, v44, v44 row_shr:4 row_mask:0xf bank_mask:0xf bound_ctrl:1
    v_add_f32_dpp v45, v45, v45 row_shr:4 row_mask:0xf bank_mask:0xf bound_ctrl:1
    s_nop 0
    v_add_f32_dpp v44, v44, v44 row_shr:8 row_mask:0xf bank_mask:0xf bound_ctrl:1
    v_add_f32_dpp v45, v45, v45 row_shr:8 row_mask:0xf bank_mask:0xf bound_ctrl:1
    v_mul_f32 v44, s62, v44
    v_mul_f32 v45, s62, v45
    v_fma_f32 v45, -v44, v44, v45
    v_max_f32 v45, 0, v45
    v_cvt_pk_bf16_f32 v45, v45, v45
    v_and_b32 v45, 0xffff0000, v45
    v_add_f32 v45, s63, v45
    v_cvt_pk_bf16_f32 v45, v45, v45
    v_and_b32 v45, 0xffff0000, v45
    v_sqrt_f32 v45, v45
    v_cvt_pk_bf16_f32 v44, v44, v44
    v_and_b32 v44, 0xffff0000, v44
    v_cvt_pk_bf16_f32 v45, v45, v45
    v_and_b32 v45, 0xffff0000, v45
    v_rcp_f32 v45, v45
    s_lshl_b32 s62, s66, 5
    s_add_u32 s62, s62, 16777216
    v_lshlrev_b32 v21, 3, v2
    s_mov_b32 exec_lo, 0x80008000
    s_mov_b32 exec_hi, 0x80008000
    buffer_store_dwordx2 v[44:45], v21, s[48:51], s62 offen sc0 sc1
    s_mov_b64 exec, -1
    s_mov_b32 s70, 0
    s_lshl_b32 s64, s66, 7
    s_add_u32 s64, s64, 17629184
    s_waitcnt lgkmcnt(0)
    s_mul_i32 s68, s68, 1664525
    s_add_u32 s68, s68, 1013904223
    s_cmp_eq_u32 s57, 1
    s_cbranch_scc0 L_aux_fs
    s_barrier
L_aux_fs:
    s_waitcnt vmcnt(0)
    v_mov_b32 v19, s68
    s_mov_b64 exec, 1
    buffer_store_dword v19, off, s[48:51], s64 sc0 sc1
    s_mov_b64 exec, -1
    s_cmp_eq_u32 s57, 1
    s_cbranch_scc1 L_aux_seg
    s_barrier
L_aux_seg:
    s_cmp_eq_u32 s70, 0
    s_cbranch_scc1 L_hook0
    s_cmp_eq_u32 s70, 2
    s_cbranch_scc1 L_hook2
    s_cmp_eq_u32 s70, 4
    s_cbranch_scc1 L_hook4
    s_cmp_eq_u32 s70, 7
    s_cbranch_scc1 L_hook7
L_aux_st:
    s_add_u32 s70, s70, 1
    s_cmp_eq_u32 s70, 8
    s_cbranch_scc1 L_aux_last
    s_cmp_eq_u32 s57, 1
    s_cbranch_scc0 L_aux_seg
    s_barrier
    s_branch L_aux_seg
L_hook0:
    s_mov_b32 s61, 0
L_rb:
    s_mul_i32 s73, s61, 8192
    s_add_u32 s73, s73, 32768
    s_cmp_eq_u32 s61, 0
    s_cselect_b32 s73, 118784, s73
    v_add_u32 v21, s73, v12
    v_add_u32 v22, s73, v13
    ds_read_b128 v[72:75], v21 offset:0
    ds_read_b128 v[76:79], v22 offset:1024
    ds_read_b128 v[80:83], v21 offset:2048
    ds_read_b128 v[84:87], v22 offset:3072
    s_add_u32 s62, s58, s61
    s_and_b32 s63, s62, 31
    s_lshr_b32 s62, s62, 5
    s_lshl_b32 s62, s62, 18
    s_lshl_b32 s63, s63, 7
    s_add_u32 s64, s62, s63
    s_add_u32 s64, s64, 13631488
    s_sub_u32 s62, s62, s63
    s_add_u32 s62, s62, 10489728
    s_add_u32 s61, s61, 1
    s_waitcnt lgkmcnt(0)
    buffer_store_dwordx4 v[72:75], v4, s[48:51], s62 offen sc0 sc1
    buffer_store_dwordx4 v[76:79], v5, s[48:51], s62 offen sc0 sc1
    buffer_store_dwordx4 v[80:83], v6, s[48:51], s62 offen sc0 sc1
    buffer_store_dwordx4 v[84:87], v7, s[48:51], s62 offen sc0 sc1
    s_cmp_lt_u32 s61, s57
    s_cbranch_scc1 L_rb
    s_branch L_aux_st
L_hook2:
    v_mov_b32 v16, 163608
    v_mov_b32 v17, 1
    v_mov_b32 v19, s68
    s_lshl_b32 s62, s58, 7
    s_add_u32 s62, s62, 17301504
    s_bfm_b32 s63, s57, 0
    v_lshlrev_b32 v21, 7, v0
    s_waitcnt vmcnt(0)
    s_mov_b64 exec, 1
    ds_add_rtn_u32 v17, v16, v17
    s_mov_b64 exec, -1
    s_waitcnt lgkmcnt(0)
    v_readfirstlane_b32 s64, v17
    s_nop 0
    s_cmp_eq_u32 s64, 1
    s_cselect_b32 s62, s62, 1073741824
    s_mov_b32 exec_lo, s63
    s_mov_b32 exec_hi, 0
    buffer_store_dword v19, v21, s[48:51], s62 offen sc0 sc1
    s_mov_b64 exec, -1
    s_cmp_eq_u32 s57, 1
    s_cbranch_scc1 L_hook2b
    v_mov_b32 v18, 163608
    s_mov_b32 s69, 0
L_lwP:
    ds_read_b32 v19, v18
    s_add_u32 s69, s69, 1
    s_waitcnt lgkmcnt(0)
    v_readfirstlane_b32 s76, v19
    s_nop 0
    s_cmp_ge_u32 s76, 2
    s_cbranch_scc1 L_lwdP
    s_cmp_lt_u32 s69, 0x100000
    s_cbranch_scc1 L_lwP
L_lwdP:
L_hook2b:
    s_mul_i32 s64, s72, 40960
    s_mul_i32 s65, s53, 160
    s_add_u32 s64, s64, s65
    s_add_u32 m0, s67, 0
    s_nop 0
    buffer_load_dwordx4 v104, s[36:39], s64 offen lds
    s_add_u32 m0, s67, 1024
    s_nop 0
    buffer_load_dwordx4 v105, s[36:39], s64 offen lds
    s_add_u32 m0, s67, 2048
    s_nop 0
    buffer_load_dwordx4 v106, s[36:39], s64 offen lds
    s_add_u32 m0, s67, 3072
    s_nop 0
    buffer_load_dwordx4 v107, s[36:39], s64 offen lds
    s_add_u32 m0, s67, 4096
    s_nop 0
    buffer_load_dwordx4 v108, s[36:39], s64 offen lds
    s_branch L_aux_st
L_hook4:
    s_waitcnt vmcnt(0)
    ds_read_b64_tr_b16 v[72:73], v14 offset:0
    ds_read_b64_tr_b16 v[74:75], v14 offset:2560
    ds_read_b64_tr_b16 v[76:77], v14 offset:8
    ds_read_b64_tr_b16 v[78:79], v14 offset:2568
    ds_read_b64_tr_b16 v[80:81], v14 offset:64
    ds_read_b64_tr_b16 v[82:83], v14 offset:2624
    ds_read_b64_tr_b16 v[84:85], v14 offset:72
    ds_read_b64_tr_b16 v[86:87], v14 offset:2632
    ds_read_b64_tr_b16 v[88:89], v15 offset:128
    ds_read_b64_tr_b16 v[90:91], v15 offset:2688
    s_mul_i32 s65, s53, 54
    s_add_u32 s65, s65, s72
    s_mul_i32 s65, s65, 5120
    s_add_u32 s65, s65, 7340032
    s_cmp_ge_u32 s72, 54
    s_cselect_b32 s64, 1073741824, s65
    s_waitcnt lgkmcnt(0)
    buffer_store_dwordx4 v[72:75], v3, s[48:51], s64 offen offset:0 sc0 sc1
    buffer_store_dwordx4 v[76:79], v3, s[48:51], s64 offen offset:1024 sc0 sc1
    buffer_store_dwordx4 v[80:83], v3, s[48:51], s64 offen offset:2048 sc0 sc1
    buffer_store_dwordx4 v[84:87], v3, s[48:51], s64 offen offset:3072 sc0 sc1
    buffer_store_dwordx4 v[88:91], v11, s[48:51], s64 offen offset:0 sc0 sc1
    s_branch L_aux_st
L_hook7:
    s_lshl_b32 s62, s66, 7
    s_add_u32 s62, s62, 17367040
    s_waitcnt vmcnt(0)
    v_mov_b32 v19, s68
    s_mov_b64 exec, 1
    buffer_store_dword v19, off, s[48:51], s62 sc0 sc1
    s_mov_b64 exec, -1
    s_branch L_aux_st
L_aux_last:
    s_cmp_eq_u32 s57, 1
    s_cbranch_scc0 L_aux_nob8
    s_barrier
    s_barrier
    s_branch L_aux_over
L_aux_nob8:
    v_mov_b32 v18, 163584
    v_mov_b32 v19, 1
    s_waitcnt lgkmcnt(0)
    s_mov_b64 exec, 1
    ds_add_u32 v18, v19
    s_mov_b64 exec, -1
L_aux_over:
    s_mul_i32 s62, s54, 5
    s_lshr_b32 s62, s62, 1
    s_mul_i32 s66, s53, 80
    s_add_u32 s66, s66, s62
    s_and_b32 s71, s54, 1
    s_add_u32 s71, s71, 2
    s_cmp_eq_u32 s57, 1
    s_cselect_b32 s3, 4, 6
    s_cmp_eq_u32 s52, 3
    s_cbranch_scc1 L_cp3
    s_add_u32 s66, s66, s52
    s_mul_i32 s73, s52, 21248
    s_add_u32 s73, s73, 98304
    v_and_b32 v12, 31, v0
    v_lshlrev_b32 v12, 7, v12
    s_lshr_b32 s70, s66, 6
    s_lshl_b32 s70, s70, 12
    s_add_u32 s70, s70, 17301504
    v_mov_b32 v14, 0
    s_cmp_lt_u32 s52, s71
    s_cselect_b32 s70, s70, 1073741824
    s_branch L_cp1
L_cp3:
    s_mov_b32 s73, 98304
    s_lshl_b32 s62, s60, 13
    s_add_u32 s62, s62, 17367040
    v_and_b32 v12, 31, v0
    v_lshrrev_b32 v13, 5, v0
    v_lshl_add_u32 v12, v12, 1, v13
    v_lshl_add_u32 v12, v12, 7, s62
    s_mul_i32 s62, s60, 80
    s_lshr_b32 s62, s62, 6
    s_lshl_b32 s62, s62, 5
    s_add_u32 s62, s62, s59
    s_lshl_b32 s62, s62, 7
    s_add_u32 s62, s62, 17301504
    v_and_b32 v13, 1, v0
    v_lshl_add_u32 v13, v13, 12, s62
    v_cmp_le_u32 vcc, 62, v0
    s_mov_b32 s70, 0
    v_lshlrev_b32 v14, 1, v0
    v_cndmask_b32 v12, v12, v13, vcc
L_cp1:
    s_lshl_b32 s63, s66, 1
    buffer_load_dword v16, v12, s[48:51], s70 offen sc1
    buffer_load_ushort v38, v14, s[24:27], s63 offen
    v_add_u32 v15, 1, v1
    v_and_b32 v17, 3, v15
    v_mul_u32_u24 v17, 4160, v17
    v_and_b32 v15, 28, v15
    v_lshl_add_u32 v17, v15, 1, v17
    v_lshl_add_u32 v10, v2, 4, v17
    v_add_u32 v10, s73, v10
    v_lshlrev_b32 v15, 5, v1
    s_lshl_b32 s64, s52, 12
    s_add_u32 s64, s64, 81920
    v_lshl_add_u32 v8, v2, 3, v15
    v_add_u32 v8, s64, v8
    v_add_u32 v9, s64, v3
    s_add_u32 s64, s73, 17120
    v_sub_u32 v15, s64, v15
    v_lshl_add_u32 v11, v2, 4, v15
    v_lshlrev_b32 v17, 3, v2
    v_sub_u32 v7, v15, v17
    v_add_u32 v7, 24, v7
    s_cmp_lt_u32 s52, s71
    s_cbranch_scc0 L_ywave
    s_lshl_b32 s62, s66, 12
    buffer_load_dwordx2 v[36:37], off, s[20:23], s62
    s_add_u32 m0, s73, 32
    v_add_u32 v13, s73, v3
    buffer_load_dwordx4 v3, s[20:23], s62 offen offset:0 lds
    buffer_load_dwordx4 v3, s[20:23], s62 offen offset:1024 lds
    buffer_load_dwordx4 v3, s[20:23], s62 offen offset:2048 lds
    buffer_load_dwordx4 v3, s[20:23], s62 offen offset:3072 lds
    s_waitcnt vmcnt(6)
    v_cmp_eq_u32 vcc, s68, v16
    s_nop 0
    s_cmp_eq_u64 vcc, -1
    s_cbranch_scc1 L_polldK
    s_mov_b32 s69, 0
L_pollK:
    buffer_load_dword v16, v12, s[48:51], s70 offen sc1
    s_waitcnt vmcnt(0)
    v_cmp_eq_u32 vcc, s68, v16
    s_nop 0
    s_cmp_eq_u64 vcc, -1
    s_cbranch_scc1 L_polldK
    s_sleep 4
    s_add_u32 s69, s69, 1
    s_cmp_lt_u32 s69, 0x8000
    s_cbranch_scc1 L_pollK
L_polldK:
    s_add_u32 s63, s62, 10485760
    buffer_load_dwordx4 v[20:23], v3, s[48:51], s63 offen offset:0 sc1
    buffer_load_dwordx4 v[24:27], v3, s[48:51], s63 offen offset:1024 sc1
    buffer_load_dwordx4 v[28:31], v3, s[48:51], s63 offen offset:2048 sc1
    buffer_load_dwordx4 v[32:35], v3, s[48:51], s63 offen offset:3072 sc1
    s_add_u32 s62, s73, 16640
    v_add_u32 v15, s62, v3
    v_mov_b32 v40, 0
    v_mov_b32 v41, 0
    v_mov_b32 v42, 0
    v_mov_b32 v43, 0
    s_mov_b64 exec, 0x3fffffff
    ds_write_b128 v15, v[40:43] offset:4096
    s_mov_b64 exec, -1
    v_lshrrev_b32 v16, 1, v0
    v_lshlrev_b32 v17, 4, v16
    v_sub_u32 v17, 48, v17
    v_and_b32 v18, 1, v0
    v_mul_u32_u24 v16, 4160, v16
    v_lshl_add_u32 v16, v18, 4, v16
    v_add_u32 v16, s73, v16
    v_cmp_eq_u32 vcc, 1, v18
    s_waitcnt vmcnt(4)
    ds_read_b128 v[48:51], v13 offset:32
    ds_read_b64 v[52:53], v13 offset:48
    ds_read_b128 v[54:57], v13 offset:1056
    ds_read_b64 v[58:59], v13 offset:1072
    ds_read_b128 v[60:63], v13 offset:2080
    ds_read_b64 v[64:65], v13 offset:2096
    ds_read_b128 v[66:69], v13 offset:3104
    ds_read_b64 v[70:71], v13 offset:3120
    v_lshlrev_b64 v[42:43], v17, v[36:37]
    v_lshlrev_b64 v[42:43], 16, v[42:43]
    v_cndmask_b32 v42, 0, v42, vcc
    v_cndmask_b32 v43, 0, v43, vcc
    s_mov_b64 exec, 0xff
    ds_write_b128 v16, v[40:43]
    s_mov_b64 exec, -1
    s_waitcnt lgkmcnt(7)
    v_alignbit_b32 v72, v49, v48, 16
    v_alignbit_b32 v73, v50, v49, 16
    v_alignbit_b32 v74, v51, v50, 16
    v_alignbit_b32 v75, v52, v51, 16
    ds_write_b128 v13, v[72:75] offset:4192
    v_mov_b32 v76, v49
    v_mov_b32 v77, v50
    v_mov_b32 v78, v51
    v_mov_b32 v79, v52
    ds_write_b128 v13, v[76:79] offset:8352
    v_mov_b32 v80, v73
    v_mov_b32 v81, v74
    v_mov_b32 v82, v75
    v_alignbit_b32 v83, v53, v52, 16
    ds_write_b128 v13, v[80:83] offset:12512
    s_waitcnt lgkmcnt(8)
    v_alignbit_b32 v84, v55, v54, 16
    v_alignbit_b32 v85, v56, v55, 16
    v_alignbit_b32 v86, v57, v56, 16
    v_alignbit_b32 v87, v58, v57, 16
    ds_write_b128 v13, v[84:87] offset:5216
    v_mov_b32 v88, v55
    v_mov_b32 v89, v56
    v_mov_b32 v90, v57
    v_mov_b32 v91, v58
    ds_write_b128 v13, v[88:91] offset:9376
    v_mov_b32 v92, v85
    v_mov_b32 v93, v86
    v_mov_b32 v94, v87
    v_alignbit_b32 v95, v59, v58, 16
    ds_write_b128 v13, v[92:95] offset:13536
    s_waitcnt lgkmcnt(9)
    v_alignbit_b32 v96, v61, v60, 16
    v_alignbit_b32 v97, v62, v61, 16
    v_alignbit_b32 v98, v63, v62, 16
    v_alignbit_b32 v99, v64, v63, 16
    ds_write_b128 v13, v[96:99] offset:6240
    v_mov_b32 v100, v61
    v_mov_b32 v101, v62
    v_mov_b32 v102, v63
    v_mov_b32 v103, v64
    ds_write_b128 v13, v[100:103] offset:10400
    v_mov_b32 v104, v97
    v_mov_b32 v105, v98
    v_mov_b32 v106, v99
    v_alignbit_b32 v107, v65, v64, 16
    ds_write_b128 v13, v[104:107] offset:14560
    s_waitcnt lgkmcnt(10)
    v_alignbit_b32 v108, v67, v66, 16
    v_alignbit_b32 v109, v68, v67, 16
    v_alignbit_b32 v110, v69, v68, 16
    v_alignbit_b32 v111, v70, v69, 16
    ds_write_b128 v13, v[108:111] offset:7264
    v_mov_b32 v112, v67
    v_mov_b32 v113, v68
    v_mov_b32 v114, v69
    v_mov_b32 v115, v70
    ds_write_b128 v13, v[112:115] offset:11424
    v_mov_b32 v116, v109
    v_mov_b32 v117, v110
    v_mov_b32 v118, v111
    v_alignbit_b32 v119, v71, v70, 16
    ds_write_b128 v13, v[116:119] offset:15584
    s_waitcnt vmcnt(0) lgkmcnt(8)
    ds_write_b128 v15, v[20:23] offset:0
    ds_write_b128 v15, v[24:27] offset:1024
    ds_write_b128 v15, v[28:31] offset:2048
    ds_write_b128 v15, v[32:35] offset:3072
    v_mov_b32 v18, 163592
    v_mov_b32 v19, 1
    s_waitcnt lgkmcnt(0)
    s_mov_b64 exec, 1
    ds_add_u32 v18, v19
    s_mov_b64 exec, -1
    s_branch L_staged
L_ywave:
    s_cmp_eq_u32 s52, 3
    s_cbranch_scc0 L_staged
    s_waitcnt vmcnt(1)
    v_cmp_eq_u32 vcc, s68, v16
    s_nop 0
    s_cmp_eq_u64 vcc, -1
    s_cbranch_scc1 L_polldP
    s_mov_b32 s69, 0
L_pollP:
    buffer_load_dword v16, v12, s[48:51], s70 offen sc1
    s_waitcnt vmcnt(0)
    v_cmp_eq_u32 vcc, s68, v16
    s_nop 0
    s_cmp_eq_u64 vcc, -1
    s_cbranch_scc1 L_polldP
    s_sleep 4
    s_add_u32 s69, s69, 1
    s_cmp_lt_u32 s69, 0x8000
    s_cbranch_scc1 L_pollP
L_polldP:
    v_mov_b32 v18, 163600
    v_mov_b32 v19, 1
    s_mov_b64 exec, 1
    ds_add_u32 v18, v19
    s_mov_b64 exec, -1
    s_cmp_lg_u32 s2, 0
    s_cbranch_scc1 L_staged
    v_lshlrev_b32 v13, 8, v0
    s_mov_b32 s62, 17367040
    s_mov_b32 s63, 17383424
    s_mov_b32 s64, 17399808
    s_mov_b32 s65, 17416192
    s_mov_b32 s69, 0
L_pollN:
    buffer_load_dword v16, v13, s[48:51], s62 offen sc1
    buffer_load_dword v17, v13, s[48:51], s63 offen sc1
    buffer_load_dword v18, v13, s[48:51], s64 offen sc1
    buffer_load_dword v19, v13, s[48:51], s65 offen sc1
    s_waitcnt vmcnt(0)
    v_cmp_eq_u32 vcc, s68, v16
    v_cmp_eq_u32 s[76:77], s68, v17
    s_nop 0
    s_and_b64 vcc, vcc, s[76:77]
    v_cmp_eq_u32 s[76:77], s68, v18
    s_nop 0
    s_and_b64 vcc, vcc, s[76:77]
    v_cmp_eq_u32 s[76:77], s68, v19
    s_nop 0
    s_and_b64 vcc, vcc, s[76:77]
    s_cmp_eq_u64 vcc, -1
    s_cbranch_scc1 L_polldN
    s_sleep 4
    s_add_u32 s69, s69, 1
    s_cmp_lt_u32 s69, 0x8000
    s_cbranch_scc1 L_pollN
L_polldN:
    s_mov_b32 s62, 0
    v_mov_b32 v19, s68
    s_mov_b64 exec, 1
    buffer_store_dword v19, off, s[48:51], s62 sc0 sc1
    s_mov_b64 exec, -1
L_staged:
    s_waitcnt vmcnt(0)
    v_lshlrev_b32 v38, 16, v38
    v_mov_b32 v39, v38
    v_mov_b32 v18, 163600
    s_mov_b32 s69, 0
L_lwAL:
    ds_read_b32 v19, v18
    s_add_u32 s69, s69, 1
    s_waitcnt lgkmcnt(0)
    v_readfirstlane_b32 s76, v19
    s_nop 0
    s_cmp_ge_u32 s76, 1
    s_cbranch_scc1 L_lwdAL
    s_sleep 1
    s_cmp_lt_u32 s69, 0x100000
    s_cbranch_scc1 L_lwAL
L_lwdAL:
    s_mul_i32 s72, s60, 54
    s_sub_u32 s72, s72, s52
    s_add_u32 s72, s72, 23
    s_mul_i32 s72, s72, 5120
    s_add_u32 s72, s72, 7340032
    s_mul_i32 s67, s52, 20480
    v_add_u32 v4, 4096, v3
    s_mov_b32 s74, 0
    s_cmp_lg_u32 s52, 3
    s_cbranch_scc1 L_yf
    s_cmp_eq_u32 s57, 1
    s_cbranch_scc1 L_yf
    s_mov_b32 s74, 16
    s_branch L_convY
L_yf:
    v_mov_b32 v18, 163584
    s_mov_b32 s69, 0
L_lwXL:
    ds_read_b32 v19, v18
    s_add_u32 s69, s69, 1
    s_waitcnt lgkmcnt(0)
    v_readfirstlane_b32 s76, v19
    s_nop 0
    s_cmp_ge_u32 s76, s3
    s_cbranch_scc1 L_lwdXL
    s_sleep 1
    s_cmp_lt_u32 s69, 0x100000
    s_cbranch_scc1 L_lwXL
L_lwdXL:
    s_cmp_lt_u32 s52, s71
    s_cbranch_scc1 L_convX
    s_mov_b32 s61, 0
L_burst:
    s_mov_b32 m0, s67
    s_add_u32 s67, s67, 4096
    buffer_load_dwordx4 v3, s[48:51], s72 offen offset:0 sc1 lds
    buffer_load_dwordx4 v3, s[48:51], s72 offen offset:1024 sc1 lds
    buffer_load_dwordx4 v3, s[48:51], s72 offen offset:2048 sc1 lds
    buffer_load_dwordx4 v3, s[48:51], s72 offen offset:3072 sc1 lds
    s_mov_b32 m0, s67
    s_add_u32 s67, s67, 1024
    buffer_load_dwordx4 v4, s[48:51], s72 offen sc1 lds
    s_add_u32 s72, s72, 20480
    s_add_u32 s61, s61, 1
    s_cmp_lt_u32 s61, 4
    s_cbranch_scc1 L_burst
    s_or_b32 s62, s52, s74
    s_cmp_eq_u32 s62, 3
    s_cbranch_scc1 L_convY
    s_waitcnt vmcnt(0)
    s_lshl_b32 s76, s52, 2
    s_add_u32 s76, s76, 163632
    v_mov_b32 v18, s76
    v_mov_b32 v19, 1
    s_mov_b64 exec, 1
    ds_add_u32 v18, v19
    s_mov_b64 exec, -1
    s_branch L_conv_over
L_convX:
    ds_read_b128 v[72:75], v11 offset:0
    ds_read_b64 v[40:41], v10 offset:0
    ds_read_b64 v[42:43], v10 offset:8
    ds_read_b128 v[76:79], v11 offset:512
    ds_read_b64 v[44:45], v10 offset:512
    ds_read_b64 v[46:47], v10 offset:520
    ds_read_b128 v[80:83], v11 offset:1024
    ds_read_b64 v[48:49], v10 offset:1024
    ds_read_b64 v[50:51], v10 offset:1032
    ds_read_b128 v[84:87], v11 offset:1536
    ds_read_b64 v[52:53], v10 offset:1536
    ds_read_b64 v[54:55], v10 offset:1544
    s_waitcnt lgkmcnt(3)
    ds_read_b128 v[88:91], v11 offset:2048
    ds_read_b64 v[56:57], v10 offset:2048
    ds_read_b64 v[58:59], v10 offset:2056
    ds_read_b128 v[92:95], v11 offset:2560
    ds_read_b64 v[60:61], v10 offset:2560
    ds_read_b64 v[62:63], v10 offset:2568
    ds_read_b128 v[96:99], v11 offset:3072
    ds_read_b64 v[64:65], v10 offset:3072
    ds_read_b64 v[66:67], v10 offset:3080
    ds_read_b128 v[100:103], v11 offset:3584
    ds_read_b64 v[68:69], v10 offset:3584
    ds_read_b64 v[70:71], v10 offset:3592
    s_lshl_b32 s76, s52, 2
    s_add_u32 s76, s76, 163616
    v_mov_b32 v18, s76
    s_mov_b32 s69, 0
L_lwGX:
    ds_read_b32 v19, v18
    s_add_u32 s69, s69, 1
    s_waitcnt lgkmcnt(0)
    v_readfirstlane_b32 s76, v19
    s_nop 0
    s_cmp_ge_u32 s76, 1
    s_cbranch_scc1 L_lwdGX
    s_sleep 1
    s_cmp_lt_u32 s69, 0x100000
    s_cbranch_scc1 L_lwGX
L_lwdGX:
    s_setprio 2
    v_mov_b32 v196, 0
    v_mov_b32 v197, 0
    v_mov_b32 v198, 0
    v_mov_b32 v199, 0
    v_mov_b32 v192, 0
    v_mov_b32 v193, 0
    v_mov_b32 v194, 0
    v_mov_b32 v195, 0
    v_mov_b32 v188, 0
    v_mov_b32 v189, 0
    v_mov_b32 v190, 0
    v_mov_b32 v191, 0
    v_mov_b32 v184, 0
    v_mov_b32 v185, 0
    v_mov_b32 v186, 0
    v_mov_b32 v187, 0
    v_mov_b32 v168, 0
    v_mov_b32 v169, 0
    v_mov_b32 v170, 0
    v_mov_b32 v171, 0
    s_mov_b32 s61, 0
L_cvX:
    s_waitcnt lgkmcnt(14)
    v_mfma_f32_16x16x32_bf16 v[196:199], v[40:43], v[72:75], v[196:199]
    ds_read_b128 v[136:139], v11 offset:64
    v_mfma_f32_16x16x32_bf16 v[192:195], v[40:43], v[76:79], v[192:195]
    ds_read_b64 v[104:105], v10 offset:64
    s_mov_b32 m0, s67
    v_mfma_f32_16x16x32_bf16 v[196:199], v[44:47], v[76:79], v[196:199]
    ds_read_b64 v[106:107], v10 offset:72
    v_mfma_f32_16x16x32_bf16 v[188:191], v[40:43], v[80:83], v[188:191]
    ds_read_b128 v[140:143], v11 offset:576
    s_add_u32 s67, s67, 4096
    v_mfma_f32_16x16x32_bf16 v[192:195], v[44:47], v[80:83], v[192:195]
    ds_read_b64 v[108:109], v10 offset:576
    v_mfma_f32_16x16x32_bf16 v[196:199], v[48:51], v[80:83], v[196:199]
    ds_read_b64 v[110:111], v10 offset:584
    buffer_load_dwordx4 v3, s[48:51], s72 offen offset:0 sc1 lds
    s_waitcnt lgkmcnt(14)
    v_mfma_f32_16x16x32_bf16 v[184:187], v[40:43], v[84:87], v[184:187]
    ds_read_b128 v[144:147], v11 offset:1088
    v_mfma_f32_16x16x32_bf16 v[188:191], v[44:47], v[84:87], v[188:191]
    ds_read_b64 v[112:113], v10 offset:1088
    buffer_load_dwordx4 v3, s[48:51], s72 offen offset:1024 sc1 lds
    v_mfma_f32_16x16x32_bf16 v[192:195], v[48:51], v[84:87], v[192:195]
    ds_read_b64 v[114:115], v10 offset:1096
    v_mfma_f32_16x16x32_bf16 v[196:199], v[52:55], v[84:87], v[196:199]
    ds_read_b128 v[148:151], v11 offset:1600
    buffer_load_dwordx4 v3, s[48:51], s72 offen offset:2048 sc1 lds
    v_mfma_f32_16x16x32_bf16 v[184:187], v[44:47], v[88:91], v[184:187]
    ds_read_b64 v[116:117], v10 offset:1600
    v_mfma_f32_16x16x32_bf16 v[188:191], v[48:51], v[88:91], v[188:191]
    ds_read_b64 v[118:119], v10 offset:1608
    buffer_load_dwordx4 v3, s[48:51], s72 offen offset:3072 sc1 lds
    v_mfma_f32_16x16x32_bf16 v[192:195], v[52:55], v[88:91], v[192:195]
    ds_read_b128 v[152:155], v11 offset:2112
    v_mfma_f32_16x16x32_bf16 v[196:199], v[56:59], v[88:91], v[196:199]
    ds_read_b64 v[120:121], v10 offset:2112
    s_mov_b32 m0, s67
    s_waitcnt lgkmcnt(14)
    v_mfma_f32_16x16x32_bf16 v[184:187], v[48:51], v[92:95], v[184:187]
    ds_read_b64 v[122:123], v10 offset:2120
    v_mfma_f32_16x16x32_bf16 v[188:191], v[52:55], v[92:95], v[188:191]
    ds_read_b128 v[156:159], v11 offset:2624
    s_add_u32 s67, s67, 1024
    v_mfma_f32_16x16x32_bf16 v[192:195], v[56:59], v[92:95], v[192:195]
    ds_read_b64 v[124:125], v10 offset:2624
    v_mfma_f32_16x16x32_bf16 v[196:199], v[60:63], v[92:95], v[196:199]
    ds_read_b64 v[126:127], v10 offset:2632
    buffer_load_dwordx4 v4, s[48:51], s72 offen sc1 lds
    v_mfma_f32_16x16x32_bf16 v[184:187], v[52:55], v[96:99], v[184:187]
    ds_read_b128 v[160:163], v11 offset:3136
    v_mfma_f32_16x16x32_bf16 v[188:191], v[56:59], v[96:99], v[188:191]
    ds_read_b64 v[128:129], v10 offset:3136
    s_add_u32 s72, s72, 20480
    v_mfma_f32_16x16x32_bf16 v[192:195], v[60:63], v[96:99], v[192:195]
    ds_read_b64 v[130:131], v10 offset:3144
    v_mfma_f32_16x16x32_bf16 v[196:199], v[64:67], v[96:99], v[196:199]
    ds_read_b128 v[164:167], v11 offset:3648
    v_mfma_f32_16x16x32_bf16 v[168:171], v[40:43], v[100:103], v[168:171]
    ds_read_b64 v[132:133], v10 offset:3648
    v_mfma_f32_16x16x32_bf16 v[184:187], v[56:59], v[100:103], v[184:187]
    ds_read_b64 v[134:135], v10 offset:3656
    v_mfma_f32_16x16x32_bf16 v[188:191], v[60:63], v[100:103], v[188:191]
    v_mfma_f32_16x16x32_bf16 v[192:195], v[64:67], v[100:103], v[192:195]
    v_mfma_f32_16x16x32_bf16 v[196:199], v[68:71], v[100:103], v[196:199]
    s_waitcnt lgkmcnt(14)
    v_mfma_f32_16x16x32_bf16 v[196:199], v[104:107], v[136:139], v[196:199]
    ds_read_b128 v[72:75], v11 offset:128
    v_mfma_f32_16x16x32_bf16 v[192:195], v[104:107], v[140:143], v[192:195]
    ds_read_b64 v[40:41], v10 offset:128
    v_mfma_f32_16x16x32_bf16 v[196:199], v[108:111], v[140:143], v[196:199]
    ds_read_b64 v[42:43], v10 offset:136
    v_mfma_f32_16x16x32_bf16 v[188:191], v[104:107], v[144:147], v[188:191]
    ds_read_b128 v[76:79], v11 offset:640
    v_mfma_f32_16x16x32_bf16 v[192:195], v[108:111], v[144:147], v[192:195]
    ds_read_b64 v[44:45], v10 offset:640
    v_mfma_f32_16x16x32_bf16 v[196:199], v[112:115], v[144:147], v[196:199]
    ds_read_b64 v[46:47], v10 offset:648
    s_waitcnt lgkmcnt(14)
    v_mfma_f32_16x16x32_bf16 v[184:187], v[104:107], v[148:151], v[184:187]
    ds_read_b128 v[80:83], v11 offset:1152
    v_mfma_f32_16x16x32_bf16 v[188:191], v[108:111], v[148:151], v[188:191]
    ds_read_b64 v[48:49], v10 offset:1152
    v_mfma_f32_16x16x32_bf16 v[192:195], v[112:115], v[148:151], v[192:195]
    ds_read_b64 v[50:51], v10 offset:1160
    v_mfma_f32_16x16x32_bf16 v[196:199], v[116:119], v[148:151], v[196:199]
    ds_read_b128 v[84:87], v11 offset:1664
    v_mfma_f32_16x16x32_bf16 v[184:187], v[108:111], v[152:155], v[184:187]
    ds_read_b64 v[52:53], v10 offset:1664
    v_mfma_f32_16x16x32_bf16 v[188:191], v[112:115], v[152:155], v[188:191]
    ds_read_b64 v[54:55], v10 offset:1672
    v_mfma_f32_16x16x32_bf16 v[192:195], v[116:119], v[152:155], v[192:195]
    ds_read_b128 v[88:91], v11 offset:2176
    v_mfma_f32_16x16x32_bf16 v[196:199], v[120:123], v[152:155], v[196:199]
    ds_read_b64 v[56:57], v10 offset:2176
    s_waitcnt lgkmcnt(14)
    v_mfma_f32_16x16x32_bf16 v[184:187], v[112:115], v[156:159], v[184:187]
    ds_read_b64 v[58:59], v10 offset:2184
    v_mfma_f32_16x16x32_bf16 v[188:191], v[116:119], v[156:159], v[188:191]
    ds_read_b128 v[92:95], v11 offset:2688
    v_mfma_f32_16x16x32_bf16 v[192:195], v[120:123], v[156:159], v[192:195]
    ds_read_b64 v[60:61], v10 offset:2688
    v_mfma_f32_16x16x32_bf16 v[196:199], v[124:127], v[156:159], v[196:199]
    ds_read_b64 v[62:63], v10 offset:2696
    v_mfma_f32_16x16x32_bf16 v[184:187], v[116:119], v[160:163], v[184:187]
    ds_read_b128 v[96:99], v11 offset:3200
    v_mfma_f32_16x16x32_bf16 v[188:191], v[120:123], v[160:163], v[188:191]
    ds_read_b64 v[64:65], v10 offset:3200
    v_mfma_f32_16x16x32_bf16 v[192:195], v[124:127], v[160:163], v[192:195]
    ds_read_b64 v[66:67], v10 offset:3208
    v_mfma_f32_16x16x32_bf16 v[196:199], v[128:131], v[160:163], v[196:199]
    ds_read_b128 v[100:103], v11 offset:3712
    v_mfma_f32_16x16x32_bf16 v[168:171], v[104:107], v[164:167], v[168:171]
    ds_read_b64 v[68:69], v10 offset:3712
    v_mfma_f32_16x16x32_bf16 v[184:187], v[120:123], v[164:167], v[184:187]
    ds_read_b64 v[70:71], v10 offset:3720
    v_add_u32 v10, 128, v10
    v_add_u32 v11, 128, v11
    v_mfma_f32_16x16x32_bf16 v[188:191], v[124:127], v[164:167], v[188:191]
    s_add_u32 s61, s61, 1
    s_cmp_lt_u32 s61, 4
    v_mfma_f32_16x16x32_bf16 v[192:195], v[128:131], v[164:167], v[192:195]
    v_mfma_f32_16x16x32_bf16 v[196:199], v[132:135], v[164:167], v[196:199]
    s_cbranch_scc1 L_cvX
    s_waitcnt lgkmcnt(0)
    ds_read_b64 v[200:201], v7 offset:1536
    ds_read_b64 v[202:203], v7 offset:1024
    ds_read_b64 v[204:205], v7 offset:512
    ds_read_b64 v[206:207], v7 offset:0
    ds_read_b64 v[208:209], v7 offset:3584
    s_lshl_b32 s62, s66, 12
    s_add_u32 s62, s62, 13631488
    s_waitcnt lgkmcnt(0)
    v_and_b32 v216, 0xffff0000, v201
    v_lshlrev_b32 v217, 16, v201
    v_and_b32 v218, 0xffff0000, v200
    v_lshlrev_b32 v219, 16, v200
    v_pk_fma_f32 v[184:185], v[216:217], v[38:39], v[184:185]
    v_pk_fma_f32 v[186:187], v[218:219], v[38:39], v[186:187]
    v_cvt_pk_bf16_f32 v200, v184, v185
    v_cvt_pk_bf16_f32 v201, v186, v187
    ds_write_b64 v8, v[200:201] offset:0
    v_and_b32 v216, 0xffff0000, v203
    v_lshlrev_b32 v217, 16, v203
    v_and_b32 v218, 0xffff0000, v202
    v_lshlrev_b32 v219, 16, v202
    v_pk_fma_f32 v[188:189], v[216:217], v[38:39], v[188:189]
    v_pk_fma_f32 v[190:191], v[218:219], v[38:39], v[190:191]
    v_cvt_pk_bf16_f32 v202, v188, v189
    v_cvt_pk_bf16_f32 v203, v190, v191
    ds_write_b64 v8, v[202:203] offset:512
    v_and_b32 v216, 0xffff0000, v205
    v_lshlrev_b32 v217, 16, v205
    v_and_b32 v218, 0xffff0000, v204
    v_lshlrev_b32 v219, 16, v204
    v_pk_fma_f32 v[192:193], v[216:217], v[38:39], v[192:193]
    v_pk_fma_f32 v[194:195], v[218:219], v[38:39], v[194:195]
    v_cvt_pk_bf16_f32 v204, v192, v193
    v_cvt_pk_bf16_f32 v205, v194, v195
    ds_write_b64 v8, v[204:205] offset:1024
    v_and_b32 v216, 0xffff0000, v207
    v_lshlrev_b32 v217, 16, v207
    v_and_b32 v218, 0xffff0000, v206
    v_lshlrev_b32 v219, 16, v206
    v_pk_fma_f32 v[196:197], v[216:217], v[38:39], v[196:197]
    v_pk_fma_f32 v[198:199], v[218:219], v[38:39], v[198:199]
    v_cvt_pk_bf16_f32 v206, v196, v197
    v_cvt_pk_bf16_f32 v207, v198, v199
    ds_write_b64 v8, v[206:207] offset:1536
    v_and_b32 v216, 0xffff0000, v209
    v_lshlrev_b32 v217, 16, v209
    v_and_b32 v218, 0xffff0000, v208
    v_lshlrev_b32 v219, 16, v208
    v_pk_fma_f32 v[168:169], v[216:217], v[38:39], v[168:169]
    v_pk_fma_f32 v[170:171], v[218:219], v[38:39], v[170:171]
    v_cvt_pk_bf16_f32 v208, v168, v169
    v_cvt_pk_bf16_f32 v209, v170, v171
    ds_write_b64 v8, v[208:209] offset:2048
    s_waitcnt lgkmcnt(0)
    ds_read_b128 v[220:223], v9 offset:0
    ds_read_b128 v[224:227], v9 offset:1024
    ds_read_b128 v[228:231], v9 offset:2048
    s_waitcnt lgkmcnt(2)
    buffer_store_dwordx4 v[220:223], v3, s[48:51], s62 offen offset:2048 sc0 sc1
    s_waitcnt lgkmcnt(1)
    buffer_store_dwordx4 v[224:227], v3, s[48:51], s62 offen offset:3072 sc0 sc1
    s_waitcnt lgkmcnt(0)
    s_mov_b32 exec_hi, 0
    buffer_store_dwordx4 v[228:231], v3, s[48:51], s62 offen offset:0 sc0 sc1
    s_mov_b32 exec_hi, -1
    s_waitcnt vmcnt(3)
    s_lshl_b32 s76, s52, 2
    s_add_u32 s76, s76, 163632
    v_mov_b32 v18, s76
    v_mov_b32 v19, 1
    s_mov_b64 exec, 1
    ds_add_u32 v18, v19
    s_mov_b64 exec, -1
    s_branch L_conv_sig
L_convY:
    v_mov_b32 v18, 163592
    s_mov_b32 s69, 0
L_lwS:
    ds_read_b32 v19, v18
    s_add_u32 s69, s69, 1
    s_waitcnt lgkmcnt(0)
    v_readfirstlane_b32 s76, v19
    s_nop 0
    s_cmp_ge_u32 s76, s71
    s_cbranch_scc1 L_lwdS
    s_sleep 1
    s_cmp_lt_u32 s69, 0x100000
    s_cbranch_scc1 L_lwS
L_lwdS:
    ds_read_b128 v[88:91], v11 offset:2048
    ds_read_b64 v[40:41], v10 offset:0
    ds_read_b64 v[42:43], v10 offset:8
    ds_read_b128 v[92:95], v11 offset:2560
    ds_read_b64 v[44:45], v10 offset:512
    ds_read_b64 v[46:47], v10 offset:520
    ds_read_b128 v[96:99], v11 offset:3072
    ds_read_b64 v[48:49], v10 offset:1024
    ds_read_b64 v[50:51], v10 offset:1032
    ds_read_b128 v[100:103], v11 offset:3584
    ds_read_b64 v[52:53], v10 offset:1536
    ds_read_b64 v[54:55], v10 offset:1544
    s_lshl_b32 s76, s52, 2
    s_add_u32 s76, s76, 163616
    v_mov_b32 v18, s76
    s_mov_b32 s69, 0
L_lwGY:
    ds_read_b32 v19, v18
    s_add_u32 s69, s69, 1
    s_waitcnt lgkmcnt(0)
    v_readfirstlane_b32 s76, v19
    s_nop 0
    s_cmp_ge_u32 s76, 1
    s_cbranch_scc1 L_lwdGY
    s_sleep 1
    s_cmp_lt_u32 s69, 0x100000
    s_cbranch_scc1 L_lwGY
L_lwdGY:
    s_setprio 2
    s_mov_b32 s75, 0
L_cy:
    v_mov_b32 v180, 0
    v_mov_b32 v181, 0
    v_mov_b32 v182, 0
    v_mov_b32 v183, 0
    v_mov_b32 v176, 0
    v_mov_b32 v177, 0
    v_mov_b32 v178, 0
    v_mov_b32 v179, 0
    v_mov_b32 v172, 0
    v_mov_b32 v173, 0
    v_mov_b32 v174, 0
    v_mov_b32 v175, 0
    s_mov_b32 s61, 0
L_cvY:
    s_waitcnt lgkmcnt(9)
    v_mfma_f32_16x16x32_bf16 v[180:183], v[40:43], v[88:91], v[180:183]
    ds_read_b128 v[152:155], v11 offset:2112
    ds_read_b64 v[104:105], v10 offset:64
    s_waitcnt lgkmcnt(8)
    v_mfma_f32_16x16x32_bf16 v[176:179], v[40:43], v[92:95], v[176:179]
    ds_read_b64 v[106:107], v10 offset:72
    ds_read_b128 v[156:159], v11 offset:2624
    v_mfma_f32_16x16x32_bf16 v[180:183], v[44:47], v[92:95], v[180:183]
    ds_read_b64 v[108:109], v10 offset:576
    ds_read_b64 v[110:111], v10 offset:584
    s_waitcnt lgkmcnt(9)
    v_mfma_f32_16x16x32_bf16 v[172:175], v[40:43], v[96:99], v[172:175]
    ds_read_b128 v[160:163], v11 offset:3136
    ds_read_b64 v[112:113], v10 offset:1088
    v_mfma_f32_16x16x32_bf16 v[176:179], v[44:47], v[96:99], v[176:179]
    ds_read_b64 v[114:115], v10 offset:1096
    ds_read_b128 v[164:167], v11 offset:3648
    v_mfma_f32_16x16x32_bf16 v[180:183], v[48:51], v[96:99], v[180:183]
    ds_read_b64 v[116:117], v10 offset:1600
    ds_read_b64 v[118:119], v10 offset:1608
    s_cmp_eq_u32 s61, 3
    s_cselect_b32 s64, 20736, 0
    s_waitcnt lgkmcnt(12)
    v_mfma_f32_16x16x32_bf16 v[172:175], v[44:47], v[100:103], v[172:175]
    v_add_u32 v10, s64, v10
    v_add_u32 v11, s64, v11
    v_mfma_f32_16x16x32_bf16 v[176:179], v[48:51], v[100:103], v[176:179]
    v_mfma_f32_16x16x32_bf16 v[180:183], v[52:55], v[100:103], v[180:183]
    s_waitcnt lgkmcnt(9)
    v_mfma_f32_16x16x32_bf16 v[180:183], v[104:107], v[152:155], v[180:183]
    ds_read_b128 v[88:91], v11 offset:2176
    ds_read_b64 v[40:41], v10 offset:128
    s_waitcnt lgkmcnt(8)
    v_mfma_f32_16x16x32_bf16 v[176:179], v[104:107], v[156:159], v[176:179]
    ds_read_b64 v[42:43], v10 offset:136
    ds_read_b128 v[92:95], v11 offset:2688
    v_mfma_f32_16x16x32_bf16 v[180:183], v[108:111], v[156:159], v[180:183]
    ds_read_b64 v[44:45], v10 offset:640
    ds_read_b64 v[46:47], v10 offset:648
    s_waitcnt lgkmcnt(9)
    v_mfma_f32_16x16x32_bf16 v[172:175], v[104:107], v[160:163], v[172:175]
    ds_read_b128 v[96:99], v11 offset:3200
    ds_read_b64 v[48:49], v10 offset:1152
    v_mfma_f32_16x16x32_bf16 v[176:179], v[108:111], v[160:163], v[176:179]
    ds_read_b64 v[50:51], v10 offset:1160
    ds_read_b128 v[100:103], v11 offset:3712
    v_mfma_f32_16x16x32_bf16 v[180:183], v[112:115], v[160:163], v[180:183]
    ds_read_b64 v[52:53], v10 offset:1664
    ds_read_b64 v[54:55], v10 offset:1672
    v_add_u32 v10, 128, v10
    v_add_u32 v11, 128, v11
    s_waitcnt lgkmcnt(12)
    v_mfma_f32_16x16x32_bf16 v[172:175], v[108:111], v[164:167], v[172:175]
    s_add_u32 s61, s61, 1
    s_cmp_lt_u32 s61, 4
    v_mfma_f32_16x16x32_bf16 v[176:179], v[112:115], v[164:167], v[176:179]
    v_mfma_f32_16x16x32_bf16 v[180:183], v[116:119], v[164:167], v[180:183]
    s_cbranch_scc0 L_cvdY
    s_or_b32 s63, s61, s74
    s_cmp_lg_u32 s63, 2
    s_cbranch_scc1 L_cvY
    s_waitcnt vmcnt(0)
    s_mov_b32 s74, 8
    s_lshl_b32 s76, s52, 2
    s_add_u32 s76, s76, 163632
    v_mov_b32 v18, s76
    v_mov_b32 v19, 1
    s_mov_b64 exec, 1
    ds_add_u32 v18, v19
    s_mov_b64 exec, -1
    s_branch L_cvY
L_cvdY:
    s_waitcnt lgkmcnt(0)
    ds_read_b64 v[200:201], v7 offset:3072
    ds_read_b64 v[202:203], v7 offset:2560
    ds_read_b64 v[204:205], v7 offset:2048
    v_readlane_b32 s62, v38, s75
    s_nop 1
    v_mov_b32 v232, s62
    v_mov_b32 v233, s62
    s_lshl_b32 s62, s66, 12
    s_add_u32 s62, s62, 13631488
    s_waitcnt lgkmcnt(0)
    v_and_b32 v216, 0xffff0000, v201
    v_lshlrev_b32 v217, 16, v201
    v_and_b32 v218, 0xffff0000, v200
    v_lshlrev_b32 v219, 16, v200
    v_pk_fma_f32 v[172:173], v[216:217], v[232:233], v[172:173]
    v_pk_fma_f32 v[174:175], v[218:219], v[232:233], v[174:175]
    v_cvt_pk_bf16_f32 v200, v172, v173
    v_cvt_pk_bf16_f32 v201, v174, v175
    ds_write_b64 v8, v[200:201] offset:0
    v_and_b32 v216, 0xffff0000, v203
    v_lshlrev_b32 v217, 16, v203
    v_and_b32 v218, 0xffff0000, v202
    v_lshlrev_b32 v219, 16, v202
    v_pk_fma_f32 v[176:177], v[216:217], v[232:233], v[176:177]
    v_pk_fma_f32 v[178:179], v[218:219], v[232:233], v[178:179]
    v_cvt_pk_bf16_f32 v202, v176, v177
    v_cvt_pk_bf16_f32 v203, v178, v179
    ds_write_b64 v8, v[202:203] offset:512
    v_and_b32 v216, 0xffff0000, v205
    v_lshlrev_b32 v217, 16, v205
    v_and_b32 v218, 0xffff0000, v204
    v_lshlrev_b32 v219, 16, v204
    v_pk_fma_f32 v[180:181], v[216:217], v[232:233], v[180:181]
    v_pk_fma_f32 v[182:183], v[218:219], v[232:233], v[182:183]
    v_cvt_pk_bf16_f32 v204, v180, v181
    v_cvt_pk_bf16_f32 v205, v182, v183
    ds_write_b64 v8, v[204:205] offset:1024
    s_waitcnt lgkmcnt(0)
    ds_read_b128 v[220:223], v9 offset:0
    ds_read_b128 v[224:227], v9 offset:1024
    s_waitcnt lgkmcnt(1)
    buffer_store_dwordx4 v[220:223], v3, s[48:51], s62 offen offset:512 sc0 sc1
    s_waitcnt lgkmcnt(0)
    s_mov_b32 exec_hi, 0
    buffer_store_dwordx4 v[224:227], v3, s[48:51], s62 offen offset:1536 sc0 sc1
    s_mov_b32 exec_hi, -1
    v_add_u32 v7, 21248, v7
    s_add_u32 s66, s66, 1
    s_add_u32 s75, s75, 1
    s_cmp_lt_u32 s75, s71
    s_cbranch_scc1 L_cy
L_conv_sig:
    s_lshl_b32 s62, s53, 5
    s_add_u32 s62, s62, s54
    s_lshl_b32 s62, s62, 7
    s_add_u32 s62, s62, 17432576
    v_mov_b32 v16, 163588
    v_mov_b32 v17, 1
    s_waitcnt vmcnt(0)
    s_mov_b64 exec, 1
    ds_add_rtn_u32 v17, v16, v17
    s_waitcnt lgkmcnt(0)
    s_mov_b64 exec, -1
    v_readfirstlane_b32 s63, v17
    s_nop 0
    s_cmp_lg_u32 s63, s71
    s_cbranch_scc1 L_conv_done
    v_mov_b32 v19, s68
    s_mov_b64 exec, 1
    buffer_store_dword v19, off, s[48:51], s62 sc0 sc1
    s_mov_b64 exec, -1
L_conv_done:
    s_cmp_eq_u32 s74, 16
    s_cbranch_scc1 L_yf
L_conv_over:
    s_add_u32 s71, s71, 1
    s_setprio 2
    v_mov_b32 v18, 163588
    s_mov_b32 s69, 0
L_lwZ:
    ds_read_b32 v19, v18
    s_add_u32 s69, s69, 1
    s_waitcnt lgkmcnt(0)
    v_readfirstlane_b32 s76, v19
    s_nop 0
    s_cmp_ge_u32 s76, s71
    s_cbranch_scc1 L_lwdZ
    s_sleep 2
    s_cmp_lt_u32 s69, 0x100000
    s_cbranch_scc1 L_lwZ
L_lwdZ:
    s_lshl_b32 s62, s59, 6
    s_lshl_b32 s63, s52, 4
    s_add_u32 s70, s62, s63
    s_mul_i32 s62, s70, 1280
    s_mul_i32 s64, s60, 160
    s_add_u32 s62, s62, s64
    s_mul_i32 s73, s52, 5120
    s_add_u32 s73, s73, 98304
    v_add_u32 v21, 0, v0
    v_mul_u32_u24 v22, 6554, v21
    v_lshrrev_b32 v22, 16, v22
    v_mul_u32_u24 v23, 10, v22
    v_sub_u32 v23, v21, v23
    v_mul_u32_u24 v22, 1280, v22
    v_lshl_add_u32 v22, v23, 4, v22
    s_add_u32 m0, s73, 2560
    s_nop 0
    buffer_load_dwordx4 v22, s[4:7], s62 offen lds
    v_add_u32 v21, 64, v0
    v_mul_u32_u24 v22, 6554, v21
    v_lshrrev_b32 v22, 16, v22
    v_mul_u32_u24 v23, 10, v22
    v_sub_u32 v23, v21, v23
    v_mul_u32_u24 v22, 1280, v22
    v_lshl_add_u32 v22, v23, 4, v22
    s_add_u32 m0, s73, 3584
    s_nop 0
    buffer_load_dwordx4 v22, s[4:7], s62 offen lds
    v_add_u32 v21, 128, v0
    v_mul_u32_u24 v22, 6554, v21
    v_lshrrev_b32 v22, 16, v22
    v_mul_u32_u24 v23, 10, v22
    v_sub_u32 v23, v21, v23
    v_mul_u32_u24 v22, 1280, v22
    v_lshl_add_u32 v22, v23, 4, v22
    s_add_u32 m0, s73, 4608
    s_mov_b32 exec_hi, 0
    buffer_load_dwordx4 v22, s[4:7], s62 offen lds
    s_mov_b32 exec_hi, -1
    v_lshlrev_b32 v17, 4, v2
    v_lshlrev_b32 v18, 3, v2
    v_lshlrev_b32 v12, 3, v1
    s_lshl_b32 s63, s70, 3
    s_add_u32 s63, s63, 16777216
    buffer_load_dwordx4 v[30:33], v17, s[40:43], s64 offen
    buffer_load_dwordx4 v[34:37], v17, s[40:43], s64 offen offset:64
    buffer_load_dwordx2 v[38:39], v18, s[40:43], s64 offen offset:128
    s_lshl_b32 s62, s60, 12
    s_add_u32 s62, s62, 17432576
    v_and_b32 v14, 31, v0
    v_lshlrev_b32 v14, 7, v14
    v_mov_b32 v18, 163612
    s_mov_b32 s69, 0
L_lwH:
    ds_read_b32 v19, v18
    s_add_u32 s69, s69, 1
    s_waitcnt lgkmcnt(0)
    v_readfirstlane_b32 s76, v19
    s_nop 0
    s_cmp_ge_u32 s76, 1
    s_cbranch_scc1 L_lwdH
    s_sleep 2
    s_cmp_lt_u32 s69, 0x100000
    s_cbranch_scc1 L_lwH
L_lwdH:
    buffer_load_dwordx2 v[40:41], v12, s[48:51], s63 offen sc1
    v_add_u32 v15, s73, v3
    v_mul_u32_u24 v16, 160, v1
    v_add_u32 v16, s73, v16
    v_lshl_add_u32 v17, v2, 4, v16
    v_lshl_add_u32 v16, v2, 3, v16
    s_waitcnt vmcnt(0)
    ds_read_b128 v[20:23], v17 offset:2560
    ds_read_b128 v[24:27], v17 offset:2624
    ds_read_b64 v[28:29], v16 offset:2688
    v_lshrrev_b32 v16, 2, v0
    v_and_b32 v17, 3, v0
    v_lshlrev_b32 v17, 3, v17
    v_add_u32 v17, 118784, v17
    v_lshl_add_u32 v13, v16, 7, v17
    v_lshl_add_u32 v12, v2, 9, v13
    v_lshrrev_b32 v16, 3, v0
    v_and_b32 v17, 3, v16
    v_xor_b32 v17, s52, v17
    v_lshl_add_u32 v12, v17, 5, v12
    v_and_b32 v16, 1, v16
    v_and_b32 v17, 2, v2
    v_or_b32 v17, v17, v16
    v_xor_b32 v17, s52, v17
    v_lshl_add_u32 v13, v17, 5, v13
    v_mov_b32 v42, v41
    v_mov_b32 v43, v41
    v_mov_b32 v41, v40
    s_waitcnt lgkmcnt(0)
    v_lshlrev_b32 v68, 16, v20
    v_and_b32 v69, 0xffff0000, v20
    v_lshlrev_b32 v70, 16, v21
    v_and_b32 v71, 0xffff0000, v21
    v_lshlrev_b32 v96, 16, v30
    v_and_b32 v97, 0xffff0000, v30
    v_lshlrev_b32 v98, 16, v31
    v_and_b32 v99, 0xffff0000, v31
    v_pk_add_f32 v[104:105], v[68:69], v[40:41] neg_lo:[0,1] neg_hi:[0,1]
    v_pk_add_f32 v[106:107], v[70:71], v[40:41] neg_lo:[0,1] neg_hi:[0,1]
    v_pk_add_f32 v[68:69], v[68:69], v[96:97]
    v_pk_add_f32 v[70:71], v[70:71], v[98:99]
    v_pk_mul_f32 v[104:105], v[104:105], v[42:43]
    v_pk_mul_f32 v[106:107], v[106:107], v[42:43]
    v_lshlrev_b32 v72, 16, v22
    v_and_b32 v73, 0xffff0000, v22
    v_lshlrev_b32 v74, 16, v23
    v_and_b32 v75, 0xffff0000, v23
    v_lshlrev_b32 v96, 16, v32
    v_and_b32 v97, 0xffff0000, v32
    v_lshlrev_b32 v98, 16, v33
    v_and_b32 v99, 0xffff0000, v33
    v_pk_add_f32 v[108:109], v[72:73], v[40:41] neg_lo:[0,1] neg_hi:[0,1]
    v_pk_add_f32 v[110:111], v[74:75], v[40:41] neg_lo:[0,1] neg_hi:[0,1]
    v_pk_add_f32 v[72:73], v[72:73], v[96:97]
    v_pk_add_f32 v[74:75], v[74:75], v[98:99]
    v_pk_mul_f32 v[108:109], v[108:109], v[42:43]
    v_pk_mul_f32 v[110:111], v[110:111], v[42:43]
    v_lshlrev_b32 v76, 16, v24
    v_and_b32 v77, 0xffff0000, v24
    v_lshlrev_b32 v78, 16, v25
    v_and_b32 v79, 0xffff0000, v25
    v_lshlrev_b32 v96, 16, v34
    v_and_b32 v97, 0xffff0000, v34
    v_lshlrev_b32 v98, 16, v35
    v_and_b32 v99, 0xffff0000, v35
    v_pk_add_f32 v[112:113], v[76:77], v[40:41] neg_lo:[0,1] neg_hi:[0,1]
    v_pk_add_f32 v[114:115], v[78:79], v[40:41] neg_lo:[0,1] neg_hi:[0,1]
    v_pk_add_f32 v[76:77], v[76:77], v[96:97]
    v_pk_add_f32 v[78:79], v[78:79], v[98:99]
    v_pk_mul_f32 v[112:113], v[112:113], v[42:43]
    v_pk_mul_f32 v[114:115], v[114:115], v[42:43]
    v_lshlrev_b32 v80, 16, v26
    v_and_b32 v81, 0xffff0000, v26
    v_lshlrev_b32 v82, 16, v27
    v_and_b32 v83, 0xffff0000, v27
    v_lshlrev_b32 v96, 16, v36
    v_and_b32 v97, 0xffff0000, v36
    v_lshlrev_b32 v98, 16, v37
    v_and_b32 v99, 0xffff0000, v37
    v_pk_add_f32 v[116:117], v[80:81], v[40:41] neg_lo:[0,1] neg_hi:[0,1]
    v_pk_add_f32 v[118:119], v[82:83], v[40:41] neg_lo:[0,1] neg_hi:[0,1]
    v_pk_add_f32 v[80:81], v[80:81], v[96:97]
    v_pk_add_f32 v[82:83], v[82:83], v[98:99]
    v_pk_mul_f32 v[116:117], v[116:117], v[42:43]
    v_pk_mul_f32 v[118:119], v[118:119], v[42:43]
    v_lshlrev_b32 v84, 16, v28
    v_and_b32 v85, 0xffff0000, v28
    v_lshlrev_b32 v86, 16, v29
    v_and_b32 v87, 0xffff0000, v29
    v_lshlrev_b32 v96, 16, v38
    v_and_b32 v97, 0xffff0000, v38
    v_lshlrev_b32 v98, 16, v39
    v_and_b32 v99, 0xffff0000, v39
    v_pk_add_f32 v[120:121], v[84:85], v[40:41] neg_lo:[0,1] neg_hi:[0,1]
    v_pk_add_f32 v[122:123], v[86:87], v[40:41] neg_lo:[0,1] neg_hi:[0,1]
    v_pk_add_f32 v[84:85], v[84:85], v[96:97]
    v_pk_add_f32 v[86:87], v[86:87], v[98:99]
    v_pk_mul_f32 v[120:121], v[120:121], v[42:43]
    v_pk_mul_f32 v[122:123], v[122:123], v[42:43]
    s_cmp_eq_u32 s52, 0
    s_cbranch_scc0 L_zwait
    v_lshrrev_b32 v8, 3, v0
    v_lshrrev_b32 v9, 3, v0
    v_and_b32 v9, 2, v9
    v_and_b32 v10, 7, v0
    v_xor_b32 v10, v10, v9
    v_lshlrev_b32 v8, 12, v8
    v_lshl_add_u32 v8, v10, 4, v8
    v_xor_b32 v9, 64, v8
    s_mul_i32 s64, s60, 327680
    s_lshl_b32 s63, s59, 7
    s_add_u32 s64, s64, s63
    s_add_u32 s64, s64, 13631488
    s_mov_b32 s69, 0
L_pollZ:
    buffer_load_dword v16, v14, s[48:51], s62 offen sc1
    s_waitcnt vmcnt(0)
    v_cmp_eq_u32 vcc, s68, v16
    s_nop 0
    s_cmp_eq_u64 vcc, -1
    s_cbranch_scc1 L_polldZ
    s_sleep 2
    s_add_u32 s69, s69, 1
    s_cmp_lt_u32 s69, 0x8000
    s_cbranch_scc1 L_pollZ
L_polldZ:
    s_mov_b32 m0, 118784
    s_add_u32 s63, s64, 0
    buffer_load_dwordx4 v8, s[48:51], s63 offen sc1 lds
    s_mov_b32 m0, 119808
    s_add_u32 s63, s64, 32768
    buffer_load_dwordx4 v9, s[48:51], s63 offen sc1 lds
    s_mov_b32 m0, 120832
    s_add_u32 s63, s64, 65536
    buffer_load_dwordx4 v8, s[48:51], s63 offen sc1 lds
    s_mov_b32 m0, 121856
    s_add_u32 s63, s64, 98304
    buffer_load_dwordx4 v9, s[48:51], s63 offen sc1 lds
    s_mov_b32 m0, 122880
    s_add_u32 s63, s64, 131072
    buffer_load_dwordx4 v8, s[48:51], s63 offen sc1 lds
    s_mov_b32 m0, 123904
    s_add_u32 s63, s64, 163840
    buffer_load_dwordx4 v9, s[48:51], s63 offen sc1 lds
    s_mov_b32 m0, 124928
    s_add_u32 s63, s64, 196608
    buffer_load_dwordx4 v8, s[48:51], s63 offen sc1 lds
    s_mov_b32 m0, 125952
    s_add_u32 s63, s64, 229376
    buffer_load_dwordx4 v9, s[48:51], s63 offen sc1 lds
    s_mov_b32 m0, 126976
    s_add_u32 s63, s64, 262144
    buffer_load_dwordx4 v8, s[48:51], s63 offen sc1 lds
    s_mov_b32 m0, 128000
    s_add_u32 s63, s64, 294912
    buffer_load_dwordx4 v9, s[48:51], s63 offen sc1 lds
    s_waitcnt vmcnt(0)
    v_mov_b32 v18, 163604
    v_mov_b32 v19, 1
    s_mov_b64 exec, 1
    ds_add_u32 v18, v19
    s_mov_b64 exec, -1
    s_branch L_zready
L_zwait:
    v_mov_b32 v18, 163604
    s_mov_b32 s69, 0
L_lwZR:
    ds_read_b32 v19, v18
    s_add_u32 s69, s69, 1
    s_waitcnt lgkmcnt(0)
    v_readfirstlane_b32 s76, v19
    s_nop 0
    s_cmp_ge_u32 s76, 1
    s_cbranch_scc1 L_lwdZR
    s_sleep 1
    s_cmp_lt_u32 s69, 0x100000
    s_cbranch_scc1 L_lwZR
L_lwdZR:
L_zready:
    ds_read_b64_tr_b16 v[56:57], v12 offset:0
    ds_read_b64_tr_b16 v[58:59], v12 offset:512
    ds_read_b64_tr_b16 v[60:61], v12 offset:4096
    ds_read_b64_tr_b16 v[62:63], v12 offset:4608
    ds_read_b64_tr_b16 v[64:65], v13 offset:8192
    s_waitcnt lgkmcnt(0)
    v_lshlrev_b32 v92, 16, v56
    v_and_b32 v93, 0xffff0000, v56
    v_lshlrev_b32 v94, 16, v57
    v_and_b32 v95, 0xffff0000, v57
    v_pk_fma_f32 v[68:69], v[104:105], v[92:93], v[68:69]
    v_pk_fma_f32 v[70:71], v[106:107], v[94:95], v[70:71]
    ds_write_b128 v15, v[68:71] offset:0
    v_lshlrev_b32 v92, 16, v58
    v_and_b32 v93, 0xffff0000, v58
    v_lshlrev_b32 v94, 16, v59
    v_and_b32 v95, 0xffff0000, v59
    v_pk_fma_f32 v[72:73], v[108:109], v[92:93], v[72:73]
    v_pk_fma_f32 v[74:75], v[110:111], v[94:95], v[74:75]
    ds_write_b128 v15, v[72:75] offset:1024
    v_lshlrev_b32 v92, 16, v60
    v_and_b32 v93, 0xffff0000, v60
    v_lshlrev_b32 v94, 16, v61
    v_and_b32 v95, 0xffff0000, v61
    v_pk_fma_f32 v[76:77], v[112:113], v[92:93], v[76:77]
    v_pk_fma_f32 v[78:79], v[114:115], v[94:95], v[78:79]
    ds_write_b128 v15, v[76:79] offset:2048
    v_lshlrev_b32 v92, 16, v62
    v_and_b32 v93, 0xffff0000, v62
    v_lshlrev_b32 v94, 16, v63
    v_and_b32 v95, 0xffff0000, v63
    v_pk_fma_f32 v[80:81], v[116:117], v[92:93], v[80:81]
    v_pk_fma_f32 v[82:83], v[118:119], v[94:95], v[82:83]
    ds_write_b128 v15, v[80:83] offset:3072
    v_lshlrev_b32 v92, 16, v64
    v_and_b32 v93, 0xffff0000, v64
    v_lshlrev_b32 v94, 16, v65
    v_and_b32 v95, 0xffff0000, v65
    v_pk_fma_f32 v[84:85], v[120:121], v[92:93], v[84:85]
    v_pk_fma_f32 v[86:87], v[122:123], v[94:95], v[86:87]
    ds_write_b128 v15, v[84:87] offset:4096
    s_waitcnt lgkmcnt(0)
    s_barrier
    s_add_u32 s52, s52, 4
L_fin:
L_end:
    s_endpgm
.section .rodata,"a"
.p2align 6
.amdhsa_kernel parallel_sum__ssm_conv_h3__dense_activation_gelu__prompt_kernel
  .amdhsa_next_free_vgpr 256
  .amdhsa_next_free_sgpr 102
  .amdhsa_accum_offset 256
  .amdhsa_group_segment_fixed_size 0
  .amdhsa_kernarg_size 112
  .amdhsa_user_sgpr_count 2
  .amdhsa_user_sgpr_kernarg_segment_ptr 1
  .amdhsa_system_sgpr_workgroup_id_x 1
  .amdhsa_float_denorm_mode_32 3
.end_amdhsa_kernel
```
